```python
import torch

def _softmax(x, axis=-1):
    return torch.softmax(x, dim=axis)
def _gelu(x):
    return torch.nn.functional.gelu(x, approximate="tanh")
def _silu(x):
    return torch.nn.functional.silu(x)
def _sigmoid(x):
    return torch.sigmoid(x)
def _layernorm(x, axis=-1, eps=1e-5):
    m = x.mean(dim=axis, keepdim=True)
    v = x.var(dim=axis, keepdim=True, unbiased=False)
    return (x - m) / torch.sqrt(v + eps)
def _scatter_add(tgt, idx, src, axis=0):
    return tgt.clone().index_add_(axis, idx, src)
def _segment_sum(src, seg, n):
    out = torch.zeros((n,) + src.shape[1:], dtype=src.dtype)
    return out.index_add_(0, seg, src)
def _pad(x, pw):
    flat = tuple(v for pair in reversed(pw) for v in pair)
    return torch.nn.functional.pad(x, flat)

kernel_name = 'gated_mix__sliding_block_cached__dense_activation_squared_relu__decode'

def setup_inputs():

    _w = (lambda a: (lambda t: t.to(torch.bfloat16) if t.is_floating_point() else t)(torch.as_tensor(a)))
    def _A_setup():
        B, Sq, D = 2, 1, 576
        Hq, Hkv, Sk, Dh = 32, 16, 32768, 128
        assert Hq % Hkv == 0, (Hq, Hkv)
        return {
            "x": _w((lambda *s: torch.randn(*s, dtype=torch.bfloat16) * 0.05)(B, Sq, D)),
            "k_cache": _w((lambda *s: torch.randn(*s, dtype=torch.bfloat16) * 6.4)(B, Hkv, Sk, Dh)),
            "v_cache": _w((lambda *s: torch.randn(*s, dtype=torch.bfloat16) * 0.4)(B, Hkv, Sk, Dh)),
            "wq": _w((lambda *s: torch.randn(*s, dtype=torch.bfloat16) * 6.4)(D, Hq * Dh) * (D ** -0.5)),
            "wo": _w((lambda *s: torch.randn(*s, dtype=torch.bfloat16) * 0.4)(Hq * Dh, D) * ((Hq * Dh) ** -0.5)),
        }
    _A_in = _A_setup()

    def _B_setup():
        B, S, D, F = 2, 1, 576, 4608
        return {
            "x": _w((lambda *s: torch.randn(*s, dtype=torch.bfloat16) * 0.05)(B, S, D)),
            "w1": _w((lambda *s: torch.randn(*s, dtype=torch.bfloat16) * 0.05)(D, F)),
            "b1": _w((lambda *s: torch.randn(*s, dtype=torch.bfloat16) * 0.05)(F)),
            "w2": _w((lambda *s: torch.randn(*s, dtype=torch.bfloat16) * 0.05)(F, D)),
            "b2": _w((lambda *s: torch.randn(*s, dtype=torch.bfloat16) * 0.05)(D)),
        }
    _B_in = _B_setup()

    return {
        "A_x": _A_in["x"],
        "A_k_cache": _A_in["k_cache"],
        "A_v_cache": _A_in["v_cache"],
        "A_wq": _A_in["wq"],
        "A_wo": _A_in["wo"],
        "B_x": _B_in["x"],
        "B_w1": _B_in["w1"],
        "B_b1": _B_in["b1"],
        "B_w2": _B_in["w2"],
        "B_b2": _B_in["b2"],
        "gate_w": _w((lambda *s: torch.randn(*s, dtype=torch.bfloat16) * 0.05)(576) * 16.0),
    }

def reference(A_x, A_k_cache, A_v_cache, A_wq, A_wo, B_x, B_w1, B_b1, B_w2, B_b2, gate_w):
    def _A_ref(x, k_cache, v_cache, wq, wo):
        B, Sq, D = x.shape
        Hq, Dh = 32, 128
        Hkv, Sk = k_cache.shape[1], k_cache.shape[2]
        W = min(4096, max(256, Sk // 4))
        rep = Hq // Hkv
        q = (lambda x, *d: x.permute(*d))((x @ wq).reshape(B, Sq, Hq, Dh), 0, 2, 1, 3)
        k = (lambda x, n, axis: torch.repeat_interleave(x, n, dim=axis))(k_cache[:, :, Sk - W:, :], rep, axis=1)
        v = (lambda x, n, axis: torch.repeat_interleave(x, n, dim=axis))(v_cache[:, :, Sk - W:, :], rep, axis=1)
        scores = torch.einsum("bhqd,bhkd->bhqk", q, k) * (Dh ** -0.5)
        p = _softmax(scores, axis=-1)
        o = torch.einsum("bhqk,bhkd->bhqd", p, v)
        return (lambda x, *d: x.permute(*d))(o, 0, 2, 1, 3).reshape(B, Sq, Hq * Dh) @ wo

    def _B_ref(x, w1, b1, w2, b2):
        h = torch.einsum("bsd,df->bsf", x, w1) + b1
        zero = torch.zeros_like(h)
        r = torch.where(h > zero, h, zero)
        h = r * r
        out = torch.einsum("bsf,fd->bsd", h, w2) + b2
        return out

    x = A_x
    g = _sigmoid((x * gate_w).sum(-1, keepdims=True))
    a = _A_ref(x, A_k_cache, A_v_cache, A_wq, A_wo)
    b = _B_ref(x, B_w1, B_b1, B_w2, B_b2)
    return g * a + (1 - g) * b
```

```asm
; @launch grid=(256,1,1) block=(768,1,1) lds=141312
.amdgcn_target "amdgcn-amd-amdhsa--gfx950"
.text
.globl gated_mix__sliding_block_cached__dense_activation_squared_relu__decode_kernel
.p2align 8
.type gated_mix__sliding_block_cached__dense_activation_squared_relu__decode_kernel,@function
gated_mix__sliding_block_cached__dense_activation_squared_relu__decode_kernel:
    s_load_dwordx16 s[4:19], s[0:1], 0
    s_load_dwordx8 s[20:27], s[0:1], 64
    s_load_dwordx4 s[28:31], s[0:1], 96
    v_lshrrev_b32 v18, 6, v0
    v_and_b32 v1, 63, v0
    v_readfirstlane_b32 s3, v18
    s_cmp_ge_u32 s2, 256
    s_cbranch_scc1 L_end
    s_and_b32 s91, s2, 7
    s_lshr_b32 s90, s2, 3
    v_lshrrev_b32 v22, 4, v1
    v_and_b32 v23, 15, v1
    v_lshlrev_b32 v16, 4, v1
    s_cmp_lt_u32 s3, 4
    s_cbranch_scc1 L_upro
    s_sub_u32 s97, s3, 4
    s_lshl_b32 m0, s97, 14
    s_lshl_b32 s80, s91, 17
    s_lshl_b32 s85, s97, 13
    s_or_b32 s80, s80, s85
    v_lshlrev_b32 v24, 2, v22
    v_xor_b32 v24, v24, v23
    v_lshlrev_b32 v24, 4, v24
    v_lshl_add_u32 v8, v22, 8, v24
    v_xor_b32 v9, 16, v8
    v_xor_b32 v10, 32, v8
    v_xor_b32 v11, 48, v8
    v_mov_b32 v24, 0
    v_mov_b32 v25, 0
    v_lshlrev_b32 v26, 3, v1
    v_add_u32 v26, 131072, v26
    ds_write_b64 v26, v[24:25]
    s_lshl_b32 s84, s90, 23
    s_add_u32 s84, s84, 0x700000
    s_mov_b32 s34, 0x100000
    s_mov_b32 s35, 0x20000
    s_setprio 2
    s_waitcnt lgkmcnt(0)
    s_add_u32 s32, s6, s84
    s_addc_u32 s33, s7, 0
    buffer_load_dwordx4 v8, s[32:35], s80 offen offset:0 nt lds
    s_barrier
    buffer_load_dwordx4 v9, s[32:35], s80 offen offset:1024 nt lds
    buffer_load_dwordx4 v10, s[32:35], s80 offen offset:2048 nt lds
    buffer_load_dwordx4 v11, s[32:35], s80 offen offset:3072 nt lds
    s_xor_b32 s85, s80, 4096
    s_add_u32 m0, m0, 4096
    s_nop 0
    buffer_load_dwordx4 v8, s[32:35], s85 offen offset:0 nt lds
    buffer_load_dwordx4 v9, s[32:35], s85 offen offset:1024 nt lds
    buffer_load_dwordx4 v10, s[32:35], s85 offen offset:2048 nt lds
    buffer_load_dwordx4 v11, s[32:35], s85 offen offset:3072 nt lds
    s_xor_b32 s85, s80, 65536
    s_add_u32 m0, m0, 4096
    s_nop 0
    buffer_load_dwordx4 v8, s[32:35], s85 offen offset:0 nt lds
    buffer_load_dwordx4 v9, s[32:35], s85 offen offset:1024 nt lds
    buffer_load_dwordx4 v10, s[32:35], s85 offen offset:2048 nt lds
    buffer_load_dwordx4 v11, s[32:35], s85 offen offset:3072 nt lds
    s_xor_b32 s85, s80, 69632
    s_add_u32 m0, m0, 4096
    s_nop 0
    buffer_load_dwordx4 v8, s[32:35], s85 offen offset:0 nt lds
    buffer_load_dwordx4 v9, s[32:35], s85 offen offset:1024 nt lds
    buffer_load_dwordx4 v10, s[32:35], s85 offen offset:2048 nt lds
    buffer_load_dwordx4 v11, s[32:35], s85 offen offset:3072 nt lds
    s_add_u32 s36, s8, s84
    s_addc_u32 s37, s9, 0
    s_mov_b32 s38, 0x100000
    s_mov_b32 s39, 0x20000
    v_mov_b32 v2, 131072
    v_mov_b32 v3, 1
    s_mov_b32 s89, 0x3e0293ee
    s_mov_b64 exec, 1
    ds_add_u32 v2, v3 offset:36
    s_mov_b64 exec, -1
    s_setprio 1
    buffer_load_dwordx4 v[32:35], v16, s[36:39], s80 offen offset:0 nt
    buffer_load_dwordx4 v[36:39], v16, s[36:39], s80 offen offset:1024 nt
    buffer_load_dwordx4 v[40:43], v16, s[36:39], s80 offen offset:2048 nt
    buffer_load_dwordx4 v[44:47], v16, s[36:39], s80 offen offset:3072 nt
    s_xor_b32 s85, s80, 4096
    buffer_load_dwordx4 v[48:51], v16, s[36:39], s85 offen offset:0 nt
    buffer_load_dwordx4 v[52:55], v16, s[36:39], s85 offen offset:1024 nt
    buffer_load_dwordx4 v[56:59], v16, s[36:39], s85 offen offset:2048 nt
    buffer_load_dwordx4 v[60:63], v16, s[36:39], s85 offen offset:3072 nt
    s_xor_b32 s85, s80, 65536
    buffer_load_dwordx4 v[64:67], v16, s[36:39], s85 offen offset:0 nt
    buffer_load_dwordx4 v[68:71], v16, s[36:39], s85 offen offset:1024 nt
    buffer_load_dwordx4 v[72:75], v16, s[36:39], s85 offen offset:2048 nt
    buffer_load_dwordx4 v[76:79], v16, s[36:39], s85 offen offset:3072 nt
    s_xor_b32 s85, s80, 69632
    buffer_load_dwordx4 v[80:83], v16, s[36:39], s85 offen offset:0 nt
    buffer_load_dwordx4 v[84:87], v16, s[36:39], s85 offen offset:1024 nt
    buffer_load_dwordx4 v[88:91], v16, s[36:39], s85 offen offset:2048 nt
    buffer_load_dwordx4 v[92:95], v16, s[36:39], s85 offen offset:3072 nt
    s_mov_b64 exec, 1
    ds_add_u32 v2, v3 offset:28
    s_mov_b64 exec, -1
    s_branch L_amain
L_upro:
    s_setprio 3
    s_and_b32 s82, s2, 1
    s_sub_u32 s97, s3, 1
    s_movk_i32 s48, 8192
    s_mov_b32 s49, 18
    s_mov_b32 s43, 18
    s_mul_i32 s84, s91, 72
    s_mov_b32 s86, s90
    s_lshl_b32 s81, s2, 10
    s_add_u32 s81, s81, 0x80000
    s_cmp_eq_u32 s3, 0
    s_cbranch_scc1 L_ucom
    s_add_u32 s83, s2, s97
    s_cmp_eq_u32 s3, 3
    s_cselect_b32 s83, 255, s83
    s_mul_i32 s86, s83, 0x2493
    s_lshr_b32 s86, s86, 16
    s_mul_i32 s84, s86, 7
    s_sub_u32 s87, s83, s84
    s_movk_i32 s48, 9216
    s_cmp_lt_u32 s87, 2
    s_cselect_b32 s49, 22, 20
    s_mov_b32 s43, s49
    s_mul_i32 s84, s87, 80
    s_min_u32 s85, s87, 2
    s_lshl_b32 s85, s85, 3
    s_add_u32 s84, s84, s85
    s_lshl_b32 s81, s86, 3
    s_add_u32 s81, s81, s87
    s_lshl_b32 s81, s81, 10
    s_add_u32 s81, s81, 0xc0000
    s_cmp_ge_u32 s83, 252
    s_cselect_b32 s43, 0, s43
    s_cmp_lg_u32 s82, 0
    s_cselect_b32 s43, 0, s43
L_ucom:
    s_mul_i32 s85, s84, s48
    s_lshl_b32 s86, s86, 8
    s_add_u32 s85, s85, s86
    s_lshl_b32 s84, s84, 1
    v_mul_u32_u24 v26, s49, v22
    v_mul_u32_u24 v24, s48, v26
    v_lshl_add_u32 v24, v23, 4, v24
    v_lshrrev_b32 v25, 3, v23
    v_mul_u32_u24 v25, 1152, v25
    v_lshl_add_u32 v25, v26, 1, v25
    v_mov_b32 v27, 0
    s_mul_i32 s46, s48, 576
    s_mov_b32 s47, 0x20000
    s_movk_i32 s62, 2304
    s_mov_b32 s63, 0x20000
    s_mov_b32 s58, 0x40000000
    s_mov_b32 s59, 0x20000
    s_mul_i32 s86, s48, 18
    s_add_u32 s86, s86, s85
    s_cmp_eq_u32 s3, 0
    s_waitcnt lgkmcnt(0)
    s_cselect_b64 s[44:45], s[10:11], s[16:17]
    s_mov_b64 s[60:61], s[4:5]
    s_mov_b64 s[56:57], s[30:31]
    buffer_load_dword v160, v27, s[56:59], 0 offen offset:0 sc1
    s_cmp_eq_u32 s43, 0
    s_cbranch_scc1 L_unol
    buffer_load_dwordx3 v[120:122], v25, s[60:63], s84 offen offset:0
    buffer_load_dwordx3 v[124:126], v25, s[60:63], s84 offen offset:12
    buffer_load_dwordx3 v[128:130], v25, s[60:63], s84 offen offset:24
    buffer_load_dwordx3 v[132:134], v25, s[60:63], s84 offen offset:36
    s_cmp_eq_u32 s43, 18
    s_cbranch_scc1 L_umain
    buffer_load_dwordx4 v[104:107], v24, s[44:47], s86 offen nt
    s_add_u32 s86, s86, s48
    buffer_load_dwordx4 v[108:111], v24, s[44:47], s86 offen nt
    s_add_u32 s86, s86, s48
    s_cmp_eq_u32 s43, 20
    s_cbranch_scc1 L_umain
    buffer_load_dwordx4 v[112:115], v24, s[44:47], s86 offen nt
    s_add_u32 s86, s86, s48
    buffer_load_dwordx4 v[116:119], v24, s[44:47], s86 offen nt
    s_add_u32 s86, s86, s48
L_umain:
    buffer_load_dwordx4 v[32:35], v24, s[44:47], s85 offen nt
    s_add_u32 s85, s85, s48
    buffer_load_dwordx4 v[36:39], v24, s[44:47], s85 offen nt
    s_add_u32 s85, s85, s48
    buffer_load_dwordx4 v[40:43], v24, s[44:47], s85 offen nt
    s_add_u32 s85, s85, s48
    buffer_load_dwordx4 v[44:47], v24, s[44:47], s85 offen nt
    s_add_u32 s85, s85, s48
    buffer_load_dwordx4 v[48:51], v24, s[44:47], s85 offen nt
    s_add_u32 s85, s85, s48
    buffer_load_dwordx4 v[52:55], v24, s[44:47], s85 offen nt
    s_add_u32 s85, s85, s48
    buffer_load_dwordx4 v[56:59], v24, s[44:47], s85 offen nt
    s_add_u32 s85, s85, s48
    buffer_load_dwordx4 v[60:63], v24, s[44:47], s85 offen nt
    s_add_u32 s85, s85, s48
    buffer_load_dwordx4 v[64:67], v24, s[44:47], s85 offen nt
    s_add_u32 s85, s85, s48
    buffer_load_dwordx4 v[68:71], v24, s[44:47], s85 offen nt
    s_add_u32 s85, s85, s48
    buffer_load_dwordx4 v[72:75], v24, s[44:47], s85 offen nt
    s_add_u32 s85, s85, s48
    buffer_load_dwordx4 v[76:79], v24, s[44:47], s85 offen nt
    s_add_u32 s85, s85, s48
    buffer_load_dwordx4 v[80:83], v24, s[44:47], s85 offen nt
    s_add_u32 s85, s85, s48
    buffer_load_dwordx4 v[84:87], v24, s[44:47], s85 offen nt
    s_add_u32 s85, s85, s48
    buffer_load_dwordx4 v[88:91], v24, s[44:47], s85 offen nt
    s_add_u32 s85, s85, s48
    buffer_load_dwordx4 v[92:95], v24, s[44:47], s85 offen nt
    s_add_u32 s85, s85, s48
    buffer_load_dwordx4 v[96:99], v24, s[44:47], s85 offen nt
    s_add_u32 s85, s85, s48
    buffer_load_dwordx4 v[100:103], v24, s[44:47], s85 offen nt
L_unol:
    s_barrier
    v_mov_b32 v2, 131072
    v_mov_b32 v3, 1
    s_mov_b32 s89, 0x3e0293ee
    s_and_b32 s40, s90, 15
    s_lshr_b32 s41, s90, 4
    s_lshl_b32 s41, s41, 3
    s_add_u32 s41, s41, s91
    s_lshl_b32 s42, s40, 4
    s_add_u32 s42, s42, s41
    s_mov_b64 s[76:77], s[26:27]
    s_mov_b32 s78, 0x900
    s_mov_b32 s79, 0x20000
    v_and_b32 v24, 1, v23
    v_cmp_eq_u32 vcc, 1, v24
    v_mov_b32 v25, 0x0c0c0100
    v_mov_b32 v26, 0x01000c0c
    v_cndmask_b32 v25, v25, v26, vcc
    v_mov_b32 v26, 0x0c0c0302
    v_mov_b32 v27, 0x03020c0c
    v_cndmask_b32 v26, v26, v27, vcc
    v_bfe_u32 v24, v23, 1, 2
    v_mov_b32 v27, 0x0c0c0c0c
    v_cmp_eq_u32 vcc, 0, v24
    s_nop 1
    v_cndmask_b32 v136, v27, v25, vcc
    v_cndmask_b32 v140, v27, v26, vcc
    v_cmp_eq_u32 vcc, 1, v24
    s_nop 1
    v_cndmask_b32 v137, v27, v25, vcc
    v_cndmask_b32 v141, v27, v26, vcc
    v_cmp_eq_u32 vcc, 2, v24
    s_nop 1
    v_cndmask_b32 v138, v27, v25, vcc
    v_cndmask_b32 v142, v27, v26, vcc
    v_cmp_eq_u32 vcc, 3, v24
    s_nop 1
    v_cndmask_b32 v139, v27, v25, vcc
    v_cndmask_b32 v143, v27, v26, vcc
    s_mov_b32 s95, 0x0c0c0400
    s_mov_b32 s96, 0x04000c0c
    s_cmp_lg_u32 s43, 0
    s_cbranch_scc1 L_uw18
    s_waitcnt vmcnt(0)
L_uw18:
    s_waitcnt vmcnt(18)
    v_readfirstlane_b32 s94, v160
    s_nop 0
    s_and_b32 s92, s94, 0xff
    s_add_u32 s85, s94, 0x35
    s_and_b32 s85, s85, 0xff
    s_lshl_b32 s85, s85, 8
    s_or_b32 s92, s92, s85
    s_add_u32 s85, s94, 0x6b
    s_and_b32 s85, s85, 0xff
    s_lshl_b32 s85, s85, 16
    s_or_b32 s92, s92, s85
    s_add_u32 s85, s94, 0xa1
    s_and_b32 s85, s85, 0xff
    s_lshl_b32 s85, s85, 24
    s_or_b32 s92, s92, s85
    v_mov_b32 v13, s92
    s_cmp_eq_u32 s43, 0
    s_cbranch_scc1 L_udone
    v_perm_b32 v144, v120, v120, v136
    v_perm_b32 v145, v120, v120, v137
    v_perm_b32 v146, v120, v120, v138
    v_perm_b32 v147, v120, v120, v139
    s_waitcnt vmcnt(17)
    s_nop 0
    v_mfma_f32_16x16x32_bf16 v[28:31], v[144:147], v[32:35], 0
    v_perm_b32 v148, v120, v120, v140
    v_perm_b32 v149, v120, v120, v141
    v_perm_b32 v150, v120, v120, v142
    v_perm_b32 v151, v120, v120, v143
    s_waitcnt vmcnt(16)
    s_nop 0
    v_mfma_f32_16x16x32_bf16 v[28:31], v[148:151], v[36:39], v[28:31]
    v_perm_b32 v152, v121, v121, v136
    v_perm_b32 v153, v121, v121, v137
    v_perm_b32 v154, v121, v121, v138
    v_perm_b32 v155, v121, v121, v139
    s_waitcnt vmcnt(15)
    s_nop 0
    v_mfma_f32_16x16x32_bf16 v[28:31], v[152:155], v[40:43], v[28:31]
    v_perm_b32 v156, v121, v121, v140
    v_perm_b32 v157, v121, v121, v141
    v_perm_b32 v158, v121, v121, v142
    v_perm_b32 v159, v121, v121, v143
    s_waitcnt vmcnt(14)
    s_nop 0
    v_mfma_f32_16x16x32_bf16 v[28:31], v[156:159], v[44:47], v[28:31]
    v_perm_b32 v144, v122, v122, v136
    v_perm_b32 v145, v122, v122, v137
    v_perm_b32 v146, v122, v122, v138
    v_perm_b32 v147, v122, v122, v139
    s_waitcnt vmcnt(13)
    s_nop 0
    v_mfma_f32_16x16x32_bf16 v[28:31], v[144:147], v[48:51], v[28:31]
    v_perm_b32 v148, v122, v122, v140
    v_perm_b32 v149, v122, v122, v141
    v_perm_b32 v150, v122, v122, v142
    v_perm_b32 v151, v122, v122, v143
    s_waitcnt vmcnt(12)
    s_nop 0
    v_mfma_f32_16x16x32_bf16 v[28:31], v[148:151], v[52:55], v[28:31]
    v_perm_b32 v152, v124, v124, v136
    v_perm_b32 v153, v124, v124, v137
    v_perm_b32 v154, v124, v124, v138
    v_perm_b32 v155, v124, v124, v139
    s_waitcnt vmcnt(11)
    s_nop 0
    v_mfma_f32_16x16x32_bf16 v[28:31], v[152:155], v[56:59], v[28:31]
    v_perm_b32 v156, v124, v124, v140
    v_perm_b32 v157, v124, v124, v141
    v_perm_b32 v158, v124, v124, v142
    v_perm_b32 v159, v124, v124, v143
    s_waitcnt vmcnt(10)
    s_nop 0
    v_mfma_f32_16x16x32_bf16 v[28:31], v[156:159], v[60:63], v[28:31]
    v_perm_b32 v144, v125, v125, v136
    v_perm_b32 v145, v125, v125, v137
    v_perm_b32 v146, v125, v125, v138
    v_perm_b32 v147, v125, v125, v139
    s_waitcnt vmcnt(9)
    s_nop 0
    v_mfma_f32_16x16x32_bf16 v[28:31], v[144:147], v[64:67], v[28:31]
    v_perm_b32 v148, v125, v125, v140
    v_perm_b32 v149, v125, v125, v141
    v_perm_b32 v150, v125, v125, v142
    v_perm_b32 v151, v125, v125, v143
    s_waitcnt vmcnt(8)
    s_nop 0
    v_mfma_f32_16x16x32_bf16 v[28:31], v[148:151], v[68:71], v[28:31]
    v_perm_b32 v152, v126, v126, v136
    v_perm_b32 v153, v126, v126, v137
    v_perm_b32 v154, v126, v126, v138
    v_perm_b32 v155, v126, v126, v139
    s_waitcnt vmcnt(7)
    s_nop 0
    v_mfma_f32_16x16x32_bf16 v[28:31], v[152:155], v[72:75], v[28:31]
    v_perm_b32 v156, v126, v126, v140
    v_perm_b32 v157, v126, v126, v141
    v_perm_b32 v158, v126, v126, v142
    v_perm_b32 v159, v126, v126, v143
    s_waitcnt vmcnt(6)
    s_nop 0
    v_mfma_f32_16x16x32_bf16 v[28:31], v[156:159], v[76:79], v[28:31]
    v_perm_b32 v144, v128, v128, v136
    v_perm_b32 v145, v128, v128, v137
    v_perm_b32 v146, v128, v128, v138
    v_perm_b32 v147, v128, v128, v139
    s_waitcnt vmcnt(5)
    s_nop 0
    v_mfma_f32_16x16x32_bf16 v[28:31], v[144:147], v[80:83], v[28:31]
    v_perm_b32 v148, v128, v128, v140
    v_perm_b32 v149, v128, v128, v141
    v_perm_b32 v150, v128, v128, v142
    v_perm_b32 v151, v128, v128, v143
    s_waitcnt vmcnt(4)
    s_nop 0
    v_mfma_f32_16x16x32_bf16 v[28:31], v[148:151], v[84:87], v[28:31]
    v_perm_b32 v152, v129, v129, v136
    v_perm_b32 v153, v129, v129, v137
    v_perm_b32 v154, v129, v129, v138
    v_perm_b32 v155, v129, v129, v139
    s_waitcnt vmcnt(3)
    s_nop 0
    v_mfma_f32_16x16x32_bf16 v[28:31], v[152:155], v[88:91], v[28:31]
    v_perm_b32 v156, v129, v129, v140
    v_perm_b32 v157, v129, v129, v141
    v_perm_b32 v158, v129, v129, v142
    v_perm_b32 v159, v129, v129, v143
    s_waitcnt vmcnt(2)
    s_nop 0
    v_mfma_f32_16x16x32_bf16 v[28:31], v[156:159], v[92:95], v[28:31]
    v_perm_b32 v144, v130, v130, v136
    v_perm_b32 v145, v130, v130, v137
    v_perm_b32 v146, v130, v130, v138
    v_perm_b32 v147, v130, v130, v139
    s_waitcnt vmcnt(1)
    s_nop 0
    v_mfma_f32_16x16x32_bf16 v[28:31], v[144:147], v[96:99], v[28:31]
    v_perm_b32 v148, v130, v130, v140
    v_perm_b32 v149, v130, v130, v141
    v_perm_b32 v150, v130, v130, v142
    v_perm_b32 v151, v130, v130, v143
    s_waitcnt vmcnt(0)
    s_nop 0
    v_mfma_f32_16x16x32_bf16 v[28:31], v[148:151], v[100:103], v[28:31]
    s_cmp_eq_u32 s43, 18
    s_cbranch_scc1 L_upub
    v_perm_b32 v152, v132, v132, v136
    v_perm_b32 v153, v132, v132, v137
    v_perm_b32 v154, v132, v132, v138
    v_perm_b32 v155, v132, v132, v139
    s_waitcnt vmcnt(0)
    s_nop 0
    v_mfma_f32_16x16x32_bf16 v[28:31], v[152:155], v[104:107], v[28:31]
    v_perm_b32 v156, v132, v132, v140
    v_perm_b32 v157, v132, v132, v141
    v_perm_b32 v158, v132, v132, v142
    v_perm_b32 v159, v132, v132, v143
    s_waitcnt vmcnt(0)
    s_nop 0
    v_mfma_f32_16x16x32_bf16 v[28:31], v[156:159], v[108:111], v[28:31]
    s_cmp_eq_u32 s43, 20
    s_cbranch_scc1 L_upub
    v_perm_b32 v144, v133, v133, v136
    v_perm_b32 v145, v133, v133, v137
    v_perm_b32 v146, v133, v133, v138
    v_perm_b32 v147, v133, v133, v139
    s_waitcnt vmcnt(0)
    s_nop 0
    v_mfma_f32_16x16x32_bf16 v[28:31], v[144:147], v[112:115], v[28:31]
    v_perm_b32 v148, v133, v133, v140
    v_perm_b32 v149, v133, v133, v141
    v_perm_b32 v150, v133, v133, v142
    v_perm_b32 v151, v133, v133, v143
    s_waitcnt vmcnt(0)
    s_nop 0
    v_mfma_f32_16x16x32_bf16 v[28:31], v[148:151], v[116:119], v[28:31]
L_upub:
    s_nop 7
    s_mov_b32 s85, 0x07060500
    v_perm_b32 v28, v28, v13, s85
    s_add_u32 s85, s85, 1
    v_perm_b32 v29, v29, v13, s85
    s_add_u32 s85, s85, 1
    v_perm_b32 v30, v30, v13, s85
    s_add_u32 s85, s85, 1
    v_perm_b32 v31, v31, v13, s85
    buffer_store_dwordx4 v[28:31], v16, s[56:59], s81 offen sc1
L_udone:
    s_cmp_lg_u32 s3, 0
    s_cbranch_scc1 L_emain
    s_mov_b64 s[68:69], s[22:23]
    s_mov_b32 s70, 0x480
    s_mov_b32 s71, 0x20000
    v_lshrrev_b32 v24, 5, v1
    v_lshlrev_b32 v24, 13, v24
    v_and_b32 v25, 31, v1
    v_lshl_add_u32 v12, v25, 4, v24
    s_lshl_b32 s86, s40, 14
    s_lshr_b32 s85, s90, 4
    s_lshl_b32 s85, s85, 9
    s_add_u32 s86, s86, s85
    s_add_u32 s86, s86, 0x80000
    s_add_u32 s14, s86, 4096
    s_mov_b32 s88, 0
L_spin_1:
    ds_read_b32 v27, v2 offset:36
    s_add_u32 s88, s88, 1
    s_waitcnt lgkmcnt(0)
    v_readfirstlane_b32 s87, v27
    s_cmp_ge_u32 s87, 4
    s_cbranch_scc1 L_spd_2
    s_sleep 1
    s_cmp_lt_u32 s88, 262144
    s_cbranch_scc1 L_spin_1
L_spd_2:
    s_mov_b32 s88, 0
L_poll_3:
    buffer_load_dwordx4 v[32:35], v12, s[56:59], s86 offen offset:0 sc1
    buffer_load_dwordx4 v[36:39], v12, s[56:59], s86 offen offset:1024 sc1
    buffer_load_dwordx4 v[40:43], v12, s[56:59], s86 offen offset:2048 sc1
    buffer_load_dwordx4 v[44:47], v12, s[56:59], s86 offen offset:3072 sc1
    buffer_load_dwordx4 v[48:51], v12, s[56:59], s14 offen offset:0 sc1
    buffer_load_dwordx4 v[52:55], v12, s[56:59], s14 offen offset:1024 sc1
    buffer_load_dwordx4 v[56:59], v12, s[56:59], s14 offen offset:2048 sc1
    buffer_load_dwordx4 v[60:63], v12, s[56:59], s14 offen offset:3072 sc1
    s_add_u32 s88, s88, 1
    s_waitcnt vmcnt(0)
    v_perm_b32 v24, v33, v32, s95
    v_perm_b32 v25, v35, v34, s96
    v_or_b32 v24, v24, v25
    v_xor_b32 v24, v24, v13
    v_perm_b32 v26, v37, v36, s95
    v_perm_b32 v25, v39, v38, s96
    v_or_b32 v26, v26, v25
    v_xor_b32 v26, v26, v13
    v_or_b32 v24, v24, v26
    v_perm_b32 v26, v41, v40, s95
    v_perm_b32 v25, v43, v42, s96
    v_or_b32 v26, v26, v25
    v_xor_b32 v26, v26, v13
    v_or_b32 v24, v24, v26
    v_perm_b32 v26, v45, v44, s95
    v_perm_b32 v25, v47, v46, s96
    v_or_b32 v26, v26, v25
    v_xor_b32 v26, v26, v13
    v_or_b32 v24, v24, v26
    v_perm_b32 v26, v49, v48, s95
    v_perm_b32 v25, v51, v50, s96
    v_or_b32 v26, v26, v25
    v_xor_b32 v26, v26, v13
    v_or_b32 v24, v24, v26
    v_perm_b32 v26, v53, v52, s95
    v_perm_b32 v25, v55, v54, s96
    v_or_b32 v26, v26, v25
    v_xor_b32 v26, v26, v13
    v_or_b32 v24, v24, v26
    v_perm_b32 v26, v57, v56, s95
    v_perm_b32 v25, v59, v58, s96
    v_or_b32 v26, v26, v25
    v_xor_b32 v26, v26, v13
    v_or_b32 v24, v24, v26
    v_perm_b32 v26, v61, v60, s95
    v_perm_b32 v25, v63, v62, s96
    v_or_b32 v26, v26, v25
    v_xor_b32 v26, v26, v13
    v_or_b32 v24, v24, v26
    v_cmp_ne_u32 vcc, 0, v24
    s_cmp_eq_u64 vcc, 0
    s_cbranch_scc1 L_pld_4
    s_cmp_lt_u32 s88, 262144
    s_cbranch_scc1 L_poll_3
L_pld_4:
    v_and_b32 v32, 0xffffff00, v32
    v_and_b32 v33, 0xffffff00, v33
    v_and_b32 v34, 0xffffff00, v34
    v_and_b32 v35, 0xffffff00, v35
    v_and_b32 v36, 0xffffff00, v36
    v_and_b32 v37, 0xffffff00, v37
    v_and_b32 v38, 0xffffff00, v38
    v_and_b32 v39, 0xffffff00, v39
    v_and_b32 v40, 0xffffff00, v40
    v_and_b32 v41, 0xffffff00, v41
    v_and_b32 v42, 0xffffff00, v42
    v_and_b32 v43, 0xffffff00, v43
    v_and_b32 v44, 0xffffff00, v44
    v_and_b32 v45, 0xffffff00, v45
    v_and_b32 v46, 0xffffff00, v46
    v_and_b32 v47, 0xffffff00, v47
    v_and_b32 v48, 0xffffff00, v48
    v_and_b32 v49, 0xffffff00, v49
    v_and_b32 v50, 0xffffff00, v50
    v_and_b32 v51, 0xffffff00, v51
    v_and_b32 v52, 0xffffff00, v52
    v_and_b32 v53, 0xffffff00, v53
    v_and_b32 v54, 0xffffff00, v54
    v_and_b32 v55, 0xffffff00, v55
    v_and_b32 v56, 0xffffff00, v56
    v_and_b32 v57, 0xffffff00, v57
    v_and_b32 v58, 0xffffff00, v58
    v_and_b32 v59, 0xffffff00, v59
    v_and_b32 v60, 0xffffff00, v60
    v_and_b32 v61, 0xffffff00, v61
    v_and_b32 v62, 0xffffff00, v62
    v_and_b32 v63, 0xffffff00, v63
    v_add_f32 v32, v32, v48
    v_add_f32 v33, v33, v49
    v_add_f32 v34, v34, v50
    v_add_f32 v35, v35, v51
    v_add_f32 v36, v36, v52
    v_add_f32 v37, v37, v53
    v_add_f32 v38, v38, v54
    v_add_f32 v39, v39, v55
    v_add_f32 v40, v40, v56
    v_add_f32 v41, v41, v57
    v_add_f32 v42, v42, v58
    v_add_f32 v43, v43, v59
    v_add_f32 v44, v44, v60
    v_add_f32 v45, v45, v61
    v_add_f32 v46, v46, v62
    v_add_f32 v47, v47, v63
    v_add_f32 v32, v32, v40
    v_add_f32 v33, v33, v41
    v_add_f32 v34, v34, v42
    v_add_f32 v35, v35, v43
    v_add_f32 v36, v36, v44
    v_add_f32 v37, v37, v45
    v_add_f32 v38, v38, v46
    v_add_f32 v39, v39, v47
    v_add_f32 v32, v32, v36
    v_add_f32 v33, v33, v37
    v_add_f32 v34, v34, v38
    v_add_f32 v35, v35, v39
    v_cvt_pk_bf16_f32 v32, v32, v33
    v_cvt_pk_bf16_f32 v33, v34, v35
    v_lshrrev_b32 v24, 5, v1
    v_lshlrev_b32 v24, 8, v24
    v_lshl_add_u32 v24, v23, 4, v24
    v_and_b32 v25, 1, v22
    v_lshl_add_u32 v24, v25, 3, v24
    v_add_u32 v24, 132352, v24
    ds_write_b64 v24, v[32:33]
    s_mov_b64 exec, 1
    ds_add_u32 v2, v3 offset:4
    s_mov_b64 exec, -1
    v_lshrrev_b32 v24, 2, v1
    v_lshlrev_b32 v15, 4, v24
    v_lshlrev_b32 v24, 10, v24
    v_and_b32 v25, 3, v1
    v_lshl_add_u32 v14, v25, 4, v24
    s_mul_i32 s85, s2, 0xaab
    s_lshr_b32 s85, s85, 16
    s_mul_i32 s84, s85, 24
    s_sub_u32 s84, s2, s84
    s_mul_i32 s85, s85, 192
    s_lshl_b32 s86, s84, 2
    v_and_b32 v24, 3, v1
    v_add_u32 v24, s86, v24
    v_bfe_u32 v25, v24, 5, 1
    v_and_b32 v26, 15, v24
    v_lshlrev_b32 v26, 3, v26
    v_bfe_u32 v27, v24, 4, 1
    v_lshl_add_u32 v26, v27, 2, v26
    s_cmp_lt_u32 s84, 16
    s_cbranch_scc1 L_fmap
    v_bfe_u32 v25, v24, 4, 1
    v_and_b32 v26, 15, v24
    v_lshlrev_b32 v26, 2, v26
    v_add_u32 v26, 128, v26
L_fmap:
    v_and_b32 v27, 1, v22
    v_lshl_add_u32 v26, v27, 1, v26
    v_lshrrev_b32 v27, 1, v22
    v_add3_u32 v26, v26, v27, s85
    v_lshlrev_b32 v26, 1, v26
    buffer_load_ushort v8, v26, s[68:71], 0 offen
    v_mul_u32_u24 v9, 1152, v25
    v_add_u32 v9, v9, v26
    v_lshlrev_b32 v25, 4, v25
    v_add_u32 v11, 131588, v25
    v_lshrrev_b32 v24, 5, v1
    v_mul_u32_u24 v24, 192, v24
    v_and_b32 v25, 3, v1
    v_lshl_add_u32 v24, v25, 2, v24
    v_add_u32 v4, 131200, v24
    v_and_b32 v24, 1, v22
    v_mul_u32_u24 v24, 48, v24
    v_add_u32 v4, v4, v24
    s_mov_b32 s88, 0
L_spin_5:
    ds_read_b32 v27, v2 offset:8
    s_add_u32 s88, s88, 1
    s_waitcnt lgkmcnt(0)
    v_readfirstlane_b32 s87, v27
    s_cmp_ge_u32 s87, 8
    s_cbranch_scc1 L_spd_6
    s_sleep 1
    s_cmp_lt_u32 s88, 262144
    s_cbranch_scc1 L_spin_5
L_spd_6:
    v_lshlrev_b32 v24, 3, v23
    v_add_u32 v24, 131712, v24
    ds_read_b64 v[104:105], v24
    s_waitcnt lgkmcnt(0)
    v_mov_b32 v108, v104
    s_nop 1
    v_max_f32_dpp v108, v108, v108 row_ror:2 row_mask:0xf bank_mask:0xf
    s_nop 1
    v_max_f32_dpp v108, v108, v108 row_ror:4 row_mask:0xf bank_mask:0xf
    s_nop 1
    v_max_f32_dpp v108, v108, v108 row_ror:8 row_mask:0xf bank_mask:0xf
    v_sub_f32 v25, v104, v108
    v_mul_f32 v25, s89, v25
    v_exp_f32 v25, v25
    s_nop 0
    v_mul_f32 v109, v25, v105
    s_nop 1
    v_add_f32_dpp v109, v109, v109 row_ror:2 row_mask:0xf bank_mask:0xf
    s_nop 1
    v_add_f32_dpp v109, v109, v109 row_ror:4 row_mask:0xf bank_mask:0xf
    s_nop 1
    v_add_f32_dpp v109, v109, v109 row_ror:8 row_mask:0xf bank_mask:0xf
    v_mov_b32 v110, v13
    v_not_b32 v111, v13
    v_lshlrev_b32 v24, 8, v1
    s_lshl_b32 s84, s40, 9
    s_lshl_b32 s85, s41, 4
    s_add_u32 s84, s84, s85
    s_add_u32 s84, s84, 0x10000
    s_mov_b64 exec, 3
    buffer_store_dwordx4 v[108:111], v24, s[56:59], s84 offen sc1
    s_mov_b64 exec, 0xffff
    v_and_b32 v24, 1, v1
    v_lshlrev_b32 v24, 5, v24
    v_and_b32 v26, 14, v1
    v_lshl_add_u32 v24, v26, 1, v24
    v_add_u32 v24, 131648, v24
    ds_write_b32 v24, v25
    s_mov_b64 exec, -1
    v_lshrrev_b32 v24, 5, v1
    v_lshlrev_b32 v24, 5, v24
    v_add_u32 v24, 131648, v24
    ds_read_b128 v[112:115], v24
    ds_read_b128 v[116:119], v24 offset:16
    v_add_u32 v26, 133120, v16
    s_lshl_b32 s84, s40, 14
    s_lshl_b32 s85, s41, 6
    s_add_u32 s84, s84, s85
    s_add_u32 s84, s84, 0x20000
    s_lshl_b32 s86, s42, 10
    s_add_u32 s86, s86, 0x20000
    s_lshr_b32 s14, s42, 3
    s_lshl_b32 s14, s14, 8
    s_add_u32 s14, s14, 0x10000
    s_mov_b32 s88, 0
L_spin_7:
    ds_read_b32 v27, v2 offset:12
    s_add_u32 s88, s88, 1
    s_waitcnt lgkmcnt(0)
    v_readfirstlane_b32 s87, v27
    s_cmp_ge_u32 s87, 7
    s_cbranch_scc1 L_spd_8
    s_sleep 1
    s_cmp_lt_u32 s88, 262144
    s_cbranch_scc1 L_spin_7
L_spd_8:
    s_mov_b32 s88, 0
L_spin_9:
    s_waitcnt lgkmcnt(0)
    ds_read_b32 v27, v2 offset:12
    ds_read_b128 v[32:35], v26 offset:0
    ds_read_b128 v[36:39], v26 offset:1024
    ds_read_b128 v[40:43], v26 offset:2048
    ds_read_b128 v[44:47], v26 offset:3072
    ds_read_b128 v[48:51], v26 offset:4096
    ds_read_b128 v[52:55], v26 offset:5120
    ds_read_b128 v[56:59], v26 offset:6144
    ds_read_b128 v[60:63], v26 offset:7168
    s_add_u32 s88, s88, 1
    s_waitcnt lgkmcnt(8)
    v_readfirstlane_b32 s87, v27
    s_cmp_ge_u32 s87, 8
    s_cbranch_scc1 L_spd_10
    s_cmp_lt_u32 s88, 262144
    s_cbranch_scc1 L_spin_9
L_spd_10:
    s_waitcnt lgkmcnt(7)
    v_mul_f32 v120, v32, v112
    v_mul_f32 v121, v33, v112
    v_mul_f32 v122, v34, v112
    v_mul_f32 v123, v35, v112
    s_waitcnt lgkmcnt(6)
    v_fmac_f32 v120, v36, v113
    v_fmac_f32 v121, v37, v113
    v_fmac_f32 v122, v38, v113
    v_fmac_f32 v123, v39, v113
    s_waitcnt lgkmcnt(5)
    v_fmac_f32 v120, v40, v114
    v_fmac_f32 v121, v41, v114
    v_fmac_f32 v122, v42, v114
    v_fmac_f32 v123, v43, v114
    s_waitcnt lgkmcnt(4)
    v_fmac_f32 v120, v44, v115
    v_fmac_f32 v121, v45, v115
    v_fmac_f32 v122, v46, v115
    v_fmac_f32 v123, v47, v115
    s_waitcnt lgkmcnt(3)
    v_fmac_f32 v120, v48, v116
    v_fmac_f32 v121, v49, v116
    v_fmac_f32 v122, v50, v116
    v_fmac_f32 v123, v51, v116
    s_waitcnt lgkmcnt(2)
    v_fmac_f32 v120, v52, v117
    v_fmac_f32 v121, v53, v117
    v_fmac_f32 v122, v54, v117
    v_fmac_f32 v123, v55, v117
    s_waitcnt lgkmcnt(1)
    v_fmac_f32 v120, v56, v118
    v_fmac_f32 v121, v57, v118
    v_fmac_f32 v122, v58, v118
    v_fmac_f32 v123, v59, v118
    s_waitcnt lgkmcnt(0)
    v_fmac_f32 v120, v60, v119
    v_fmac_f32 v121, v61, v119
    v_fmac_f32 v122, v62, v119
    v_fmac_f32 v123, v63, v119
    s_mov_b32 s85, 0x07060500
    v_perm_b32 v120, v120, v13, s85
    s_add_u32 s85, s85, 1
    v_perm_b32 v121, v121, v13, s85
    s_add_u32 s85, s85, 1
    v_perm_b32 v122, v122, v13, s85
    s_add_u32 s85, s85, 1
    v_perm_b32 v123, v123, v13, s85
    buffer_store_dwordx4 v[120:123], v14, s[56:59], s84 offen sc1
    v_lshlrev_b32 v17, 10, v1
    s_lshl_b32 s15, s40, 6
    s_and_b32 s85, s41, 12
    s_add_u32 s15, s15, s85
    s_add_u32 s15, s15, 0x8000
    s_mov_b32 s88, 0
L_poll_11:
    buffer_load_dwordx4 v[132:135], v15, s[56:59], s14 offen sc1
    buffer_load_dwordx4 v[124:127], v16, s[56:59], s86 offen sc1
    s_add_u32 s88, s88, 1
    s_waitcnt vmcnt(0)
    v_perm_b32 v24, v125, v124, s95
    v_perm_b32 v25, v127, v126, s96
    v_or_b32 v24, v24, v25
    v_xor_b32 v24, v24, v13
    v_xor_b32 v25, v134, v110
    v_xor_b32 v26, v135, v111
    v_or3_b32 v24, v24, v25, v26
    v_cmp_ne_u32 vcc, 0, v24
    s_cmp_eq_u64 vcc, 0
    s_cbranch_scc1 L_pld_12
    s_cmp_lt_u32 s88, 262144
    s_cbranch_scc1 L_poll_11
L_pld_12:
    v_max_f32_dpp v24, v132, v132 row_ror:4 row_mask:0xf bank_mask:0xf
    v_and_b32 v124, 0xffffff00, v124
    v_and_b32 v125, 0xffffff00, v125
    v_max_f32_dpp v24, v24, v24 row_ror:8 row_mask:0xf bank_mask:0xf
    v_mov_b32 v25, v24
    v_and_b32 v126, 0xffffff00, v126
    v_and_b32 v127, 0xffffff00, v127
    v_permlane16_swap_b32 v24, v25
    v_max_f32 v24, v24, v25
    v_sub_f32 v24, v132, v24
    v_mul_f32 v24, s89, v24
    v_exp_f32 v24, v24
    s_nop 0
    v_mul_f32 v133, v133, v24
    v_mul_f32 v124, v124, v24
    v_mul_f32 v125, v125, v24
    v_mul_f32 v126, v126, v24
    v_mul_f32 v127, v127, v24
    v_mov_b32 v132, v133
    s_nop 0
    v_permlane16_swap_b32 v124, v125
    v_permlane16_swap_b32 v126, v127
    v_permlane16_swap_b32 v133, v132
    v_add_f32 v133, v133, v132
    v_add_f32 v124, v124, v125
    v_add_f32 v126, v126, v127
    v_add_f32_dpp v133, v133, v133 row_ror:4 row_mask:0xf bank_mask:0xf
    v_add_f32_dpp v124, v124, v124 row_ror:4 row_mask:0xf bank_mask:0xf
    v_add_f32_dpp v126, v126, v126 row_ror:4 row_mask:0xf bank_mask:0xf
    v_add_f32_dpp v133, v133, v133 row_ror:8 row_mask:0xf bank_mask:0xf
    v_add_f32_dpp v124, v124, v124 row_ror:8 row_mask:0xf bank_mask:0xf
    v_add_f32_dpp v126, v126, v126 row_ror:8 row_mask:0xf bank_mask:0xf
    v_rcp_f32 v133, v133
    s_nop 0
    v_mul_f32 v124, v124, v133
    v_mul_f32 v126, v126, v133
    v_cvt_pk_bf16_f32 v124, v124, v124
    v_cvt_pk_bf16_f32 v126, v126, v126
    s_mov_b32 exec_lo, 0x000f000f
    s_mov_b32 exec_hi, 0x000f000f
    ds_write_b32 v4, v124
    ds_write_b32 v4, v126 offset:96
    s_mov_b64 exec, 1
    ds_add_u32 v2, v3 offset:16
    s_mov_b64 exec, -1
    s_and_b32 s84, s41, 3
    s_cmp_lg_u32 s84, 1
    s_cbranch_scc1 L_ann_13
    s_mov_b64 exec, 0xffff
    buffer_store_dword v13, v17, s[56:59], s15 offen sc1
    s_mov_b64 exec, -1
L_ann_13:
    s_cmp_ge_u32 s2, 72
    s_cbranch_scc1 L_adone
    s_mov_b32 s88, 0
L_spin_14:
    ds_read_b32 v27, v2 offset:24
    s_add_u32 s88, s88, 1
    s_waitcnt lgkmcnt(0)
    v_readfirstlane_b32 s87, v27
    s_cmp_ge_u32 s87, 2
    s_cbranch_scc1 L_spd_15
    s_cmp_lt_u32 s88, 262144
    s_cbranch_scc1 L_spin_14
L_spd_15:
    ds_read_b32 v24, v11
    v_lshlrev_b32 v8, 16, v8
    v_and_b32 v25, 3, v1
    v_lshl_add_u32 v25, v22, 2, v25
    v_lshlrev_b32 v25, 2, v25
    v_add_u32 v25, 131840, v25
    s_waitcnt lgkmcnt(0)
    v_mul_f32 v8, v8, v24
    s_mov_b32 exec_lo, 0x000f000f
    s_mov_b32 exec_hi, 0x000f000f
    ds_write_b32 v25, v8 offset:256
    ds_write_b32 v25, v9 offset:320
    s_mov_b64 exec, -1
L_final:
    s_lshl_b32 s86, s2, 14
    s_lshl_b32 s84, s3, 12
    s_add_u32 s86, s86, s84
    s_add_u32 s86, s86, 0x200000
    v_lshlrev_b32 v27, 10, v1
    v_lshrrev_b32 v53, 24, v13
    v_and_b32 v54, 3, v1
    v_lshl_add_u32 v54, v22, 2, v54
    v_lshlrev_b32 v54, 2, v54
    v_add_u32 v54, 131840, v54
    s_lshl_b32 s84, s3, 6
    v_add_u32 v55, s84, v54
    s_cmp_eq_u32 s3, 0
    s_cbranch_scc1 L_cpoll
    s_mov_b32 s88, 0
L_spin_16:
    ds_read_b32 v27, v2 offset:20
    s_add_u32 s88, s88, 1
    s_waitcnt lgkmcnt(0)
    v_readfirstlane_b32 s87, v27
    s_cmp_ge_u32 s87, 1
    s_cbranch_scc1 L_spd_17
    s_cmp_lt_u32 s88, 262144
    s_cbranch_scc1 L_spin_16
L_spd_17:
    s_branch L_sdone2
L_cpoll:
    v_lshrrev_b32 v27, 2, v1
    v_lshlrev_b32 v27, 6, v27
    v_and_b32 v24, 3, v1
    v_lshl_add_u32 v27, v24, 2, v27
    s_and_b32 s14, s2, 15
    s_lshl_b32 s14, s14, 10
    s_lshl_b32 s84, s3, 8
    s_add_u32 s14, s14, s84
    s_add_u32 s14, s14, 0x8000
    s_mov_b64 exec, -1
    s_mov_b32 s88, 0
    v_mov_b32 v52, 0
    buffer_atomic_add v52, v27, s[56:59], s14 offen sc0
    s_sleep 8
L_sloop:
    v_mov_b32 v57, 0
    buffer_atomic_add v57, v27, s[56:59], s14 offen sc0
    s_waitcnt vmcnt(1)
    v_cmp_ne_u32 vcc, v52, v13
    s_cmp_eq_u64 vcc, 0
    s_cbranch_scc1 L_sdone
    v_mov_b32 v52, 0
    buffer_atomic_add v52, v27, s[56:59], s14 offen sc0
    s_waitcnt vmcnt(1)
    v_cmp_ne_u32 vcc, v57, v13
    s_cmp_eq_u64 vcc, 0
    s_cbranch_scc1 L_sdone
    s_add_u32 s88, s88, 1
    s_cmp_lt_u32 s88, 262144
    s_cbranch_scc1 L_sloop
L_sdone:
    s_mov_b64 exec, 1
    ds_add_u32 v2, v3 offset:20
    s_mov_b64 exec, -1
    s_mov_b64 exec, -1
L_sdone2:
    s_mov_b32 s88, 0
L_poll_18:
    buffer_load_dwordx4 v[32:35], v16, s[56:59], s86 offen offset:0 sc1
    buffer_load_dwordx4 v[36:39], v16, s[56:59], s86 offen offset:1024 sc1
    buffer_load_dwordx4 v[40:43], v16, s[56:59], s86 offen offset:2048 sc1
    buffer_load_dwordx4 v[44:47], v16, s[56:59], s86 offen offset:3072 sc1
    s_add_u32 s88, s88, 1
    s_waitcnt vmcnt(0)
    v_perm_b32 v24, v33, v32, s95
    v_perm_b32 v25, v35, v34, s96
    v_or_b32 v24, v24, v25
    v_xor_b32 v24, v24, v13
    v_perm_b32 v26, v37, v36, s95
    v_perm_b32 v25, v39, v38, s96
    v_or_b32 v26, v26, v25
    v_xor_b32 v26, v26, v13
    v_or_b32 v24, v24, v26
    v_perm_b32 v26, v41, v40, s95
    v_perm_b32 v25, v43, v42, s96
    v_or_b32 v26, v26, v25
    v_xor_b32 v26, v26, v13
    v_or_b32 v24, v24, v26
    v_perm_b32 v26, v45, v44, s95
    v_perm_b32 v25, v47, v46, s96
    v_or_b32 v26, v26, v25
    v_xor_b32 v26, v26, v13
    v_or_b32 v24, v24, v26
    v_cmp_ne_u32 vcc, 0, v24
    s_cmp_eq_u64 vcc, 0
    s_cbranch_scc1 L_pld_19
    s_cmp_lt_u32 s88, 262144
    s_cbranch_scc1 L_poll_18
L_pld_19:
    v_and_b32 v32, 0xffffff00, v32
    v_and_b32 v33, 0xffffff00, v33
    v_and_b32 v34, 0xffffff00, v34
    v_and_b32 v35, 0xffffff00, v35
    v_and_b32 v36, 0xffffff00, v36
    v_and_b32 v37, 0xffffff00, v37
    v_and_b32 v38, 0xffffff00, v38
    v_and_b32 v39, 0xffffff00, v39
    v_and_b32 v40, 0xffffff00, v40
    v_and_b32 v41, 0xffffff00, v41
    v_and_b32 v42, 0xffffff00, v42
    v_and_b32 v43, 0xffffff00, v43
    v_and_b32 v44, 0xffffff00, v44
    v_and_b32 v45, 0xffffff00, v45
    v_and_b32 v46, 0xffffff00, v46
    v_and_b32 v47, 0xffffff00, v47
    v_add_f32 v32, v32, v36
    v_add_f32 v40, v40, v44
    v_add_f32 v33, v33, v37
    v_add_f32 v41, v41, v45
    v_add_f32 v34, v34, v38
    v_add_f32 v42, v42, v46
    v_add_f32 v35, v35, v39
    v_add_f32 v43, v43, v47
    v_add_f32 v32, v32, v40
    v_add_f32 v33, v33, v41
    v_add_f32 v34, v34, v42
    v_add_f32 v35, v35, v43
    s_nop 0
    v_permlane32_swap_b32 v32, v33
    v_permlane32_swap_b32 v34, v35
    v_add_f32 v32, v32, v33
    v_add_f32 v34, v34, v35
    s_nop 1
    v_permlane16_swap_b32 v32, v34
    v_add_f32 v32, v32, v34
    s_nop 1
    v_add_f32_dpp v32, v32, v32 row_ror:4 row_mask:0xf bank_mask:0xf
    s_nop 1
    v_add_f32_dpp v32, v32, v32 row_ror:8 row_mask:0xf bank_mask:0xf
    s_mov_b32 exec_lo, 0x000f000f
    s_mov_b32 exec_hi, 0x000f000f
    ds_write_b32 v55, v32
    s_mov_b64 exec, 1
    ds_add_rtn_u32 v24, v2, v3 offset:32
    s_mov_b64 exec, -1
    ds_read_b32 v40, v54 offset:0
    ds_read_b32 v41, v54 offset:64
    ds_read_b32 v42, v54 offset:128
    ds_read_b32 v43, v54 offset:192
    ds_read_b32 v44, v54 offset:256
    ds_read_b32 v45, v54 offset:320
    s_waitcnt lgkmcnt(6)
    v_readfirstlane_b32 s84, v24
    s_cmp_lg_u32 s84, 3
    s_cbranch_scc1 L_adone
    s_waitcnt lgkmcnt(0)
    v_add_f32 v40, v40, v41
    v_add_f32 v42, v42, v43
    v_add_f32 v40, v40, v42
    v_add_f32 v40, v40, v44
    v_cvt_pk_bf16_f32 v40, v40, v40
    s_mov_b32 exec_lo, 0x000f000f
    s_mov_b32 exec_hi, 0x000f000f
    buffer_store_short v40, v45, s[76:79], 0 offen sc1
    s_mov_b64 exec, -1
    s_cmp_lg_u32 s2, 0
    s_cbranch_scc1 L_adone
    s_add_u32 s84, s94, 1
    v_mov_b32 v24, s84
    v_mov_b32 v25, 0
    s_mov_b64 exec, 1
    buffer_store_dword v24, v25, s[56:59], 0 offen offset:0 sc1
    s_mov_b64 exec, -1
    s_branch L_adone
L_emain:
    s_mov_b64 s[64:65], s[18:19]
    s_mov_b32 s66, 0x2400
    s_mov_b32 s67, 0x20000
    s_mov_b64 s[72:73], s[24:25]
    s_mov_b32 s74, 0x480
    s_mov_b32 s75, 0x20000
    s_mov_b64 s[48:49], s[12:13]
    s_mov_b32 s50, 0x480000
    s_mov_b32 s51, 0x20000
    s_mov_b64 s[52:53], s[20:21]
    s_mov_b32 s54, 0x510000
    s_mov_b32 s55, 0x20000
    s_lshr_b32 s84, s2, 1
    s_mul_i32 s80, s84, 9
    s_mul_i32 s85, s82, 5
    s_add_u32 s80, s80, s85
    s_cmp_eq_u32 s3, 2
    s_cbranch_scc1 L_ew
    s_cmp_eq_u32 s3, 3
    s_cbranch_scc1 L_eg
    v_lshrrev_b32 v27, 3, v1
    v_lshlrev_b32 v27, 10, v27
    v_bfe_u32 v24, v1, 2, 1
    v_lshl_add_u32 v27, v24, 9, v27
    v_and_b32 v24, 3, v1
    v_add_u32 v24, s80, v24
    v_lshlrev_b32 v25, 3, v24
    buffer_load_dwordx2 v[144:145], v25, s[64:67], 0 offen
    v_lshrrev_b32 v25, 5, v24
    v_lshl_add_u32 v8, v25, 13, v27
    v_and_b32 v25, 1, v24
    v_lshl_add_u32 v8, v25, 8, v8
    v_bfe_u32 v25, v24, 1, 4
    v_lshl_add_u32 v8, v25, 4, v8
    s_add_u32 s84, s80, 4
    s_min_u32 s84, s84, 1151
    v_mov_b32 v24, s84
    v_lshlrev_b32 v25, 3, v24
    buffer_load_dwordx2 v[146:147], v25, s[64:67], 0 offen
    v_lshrrev_b32 v25, 5, v24
    v_lshl_add_u32 v9, v25, 13, v27
    v_and_b32 v25, 1, v24
    v_lshl_add_u32 v9, v25, 8, v9
    v_bfe_u32 v25, v24, 1, 4
    v_lshl_add_u32 v9, v25, 4, v9
    s_mov_b32 s86, 0xc0000
    v_cmp_le_u32 vcc, 56, v1
    v_mov_b32 v24, 0x7ff00000
    s_nop 0
    v_cndmask_b32 v8, v8, v24, vcc
    v_cndmask_b32 v9, v9, v24, vcc
    s_mov_b32 s88, 0
L_spin_20:
    ds_read_b32 v27, v2 offset:36
    s_add_u32 s88, s88, 1
    s_waitcnt lgkmcnt(0)
    v_readfirstlane_b32 s87, v27
    s_cmp_ge_u32 s87, 8
    s_cbranch_scc1 L_spd_21
    s_sleep 1
    s_cmp_lt_u32 s88, 262144
    s_cbranch_scc1 L_spin_20
L_spd_21:
    s_mov_b32 s88, 0
L_poll_22:
    buffer_load_dwordx4 v[32:35], v8, s[56:59], s86 offen sc1
    buffer_load_dwordx4 v[36:39], v9, s[56:59], s86 offen sc1
    s_add_u32 s88, s88, 1
    s_waitcnt vmcnt(0)
    v_perm_b32 v24, v33, v32, s95
    v_perm_b32 v25, v35, v34, s96
    v_or_b32 v24, v24, v25
    v_xor_b32 v24, v24, v13
    v_perm_b32 v26, v37, v36, s95
    v_perm_b32 v25, v39, v38, s96
    v_or_b32 v26, v26, v25
    v_xor_b32 v26, v26, v13
    v_or_b32 v24, v24, v26
    v_cmp_ne_u32 vcc, 0, v24
    s_and_b32 vcc_hi, vcc_hi, 0x00ffffff
    s_cmp_eq_u64 vcc, 0
    s_cbranch_scc1 L_pld_23
    s_cmp_lt_u32 s88, 262144
    s_cbranch_scc1 L_poll_22
L_pld_23:
    v_and_b32 v32, 0xffffff00, v32
    v_and_b32 v33, 0xffffff00, v33
    v_and_b32 v34, 0xffffff00, v34
    v_and_b32 v35, 0xffffff00, v35
    v_and_b32 v36, 0xffffff00, v36
    v_and_b32 v37, 0xffffff00, v37
    v_and_b32 v38, 0xffffff00, v38
    v_and_b32 v39, 0xffffff00, v39
    s_nop 0
    v_add_f32_dpp v32, v32, v32 row_ror:8 row_mask:0xf bank_mask:0xf
    v_add_f32_dpp v33, v33, v33 row_ror:8 row_mask:0xf bank_mask:0xf
    v_add_f32_dpp v34, v34, v34 row_ror:8 row_mask:0xf bank_mask:0xf
    v_add_f32_dpp v35, v35, v35 row_ror:8 row_mask:0xf bank_mask:0xf
    v_add_f32_dpp v36, v36, v36 row_ror:8 row_mask:0xf bank_mask:0xf
    v_add_f32_dpp v37, v37, v37 row_ror:8 row_mask:0xf bank_mask:0xf
    v_add_f32_dpp v38, v38, v38 row_ror:8 row_mask:0xf bank_mask:0xf
    v_add_f32_dpp v39, v39, v39 row_ror:8 row_mask:0xf bank_mask:0xf
    v_mov_b32 v40, v32
    v_mov_b32 v41, v33
    v_mov_b32 v42, v34
    v_mov_b32 v43, v35
    v_mov_b32 v44, v36
    v_mov_b32 v45, v37
    v_mov_b32 v46, v38
    v_mov_b32 v47, v39
    s_nop 1
    v_permlane16_swap_b32 v32, v40
    v_permlane16_swap_b32 v33, v41
    v_permlane16_swap_b32 v34, v42
    v_permlane16_swap_b32 v35, v43
    v_permlane16_swap_b32 v36, v44
    v_permlane16_swap_b32 v37, v45
    v_permlane16_swap_b32 v38, v46
    v_permlane16_swap_b32 v39, v47
    v_add_f32 v32, v32, v40
    v_add_f32 v33, v33, v41
    v_add_f32 v34, v34, v42
    v_add_f32 v35, v35, v43
    v_add_f32 v36, v36, v44
    v_add_f32 v37, v37, v45
    v_add_f32 v38, v38, v46
    v_add_f32 v39, v39, v47
    v_mov_b32 v40, v32
    v_mov_b32 v41, v33
    v_mov_b32 v42, v34
    v_mov_b32 v43, v35
    v_mov_b32 v44, v36
    v_mov_b32 v45, v37
    v_mov_b32 v46, v38
    v_mov_b32 v47, v39
    s_nop 1
    v_permlane32_swap_b32 v32, v40
    v_permlane32_swap_b32 v33, v41
    v_permlane32_swap_b32 v34, v42
    v_permlane32_swap_b32 v35, v43
    v_permlane32_swap_b32 v36, v44
    v_permlane32_swap_b32 v37, v45
    v_permlane32_swap_b32 v38, v46
    v_permlane32_swap_b32 v39, v47
    v_add_f32 v32, v32, v40
    v_add_f32 v33, v33, v41
    v_add_f32 v34, v34, v42
    v_add_f32 v35, v35, v43
    v_add_f32 v36, v36, v44
    v_add_f32 v37, v37, v45
    v_add_f32 v38, v38, v46
    v_add_f32 v39, v39, v47
    v_lshlrev_b32 v40, 16, v144
    v_and_b32 v41, 0xffff0000, v144
    v_lshlrev_b32 v42, 16, v145
    v_and_b32 v43, 0xffff0000, v145
    v_lshlrev_b32 v44, 16, v146
    v_and_b32 v45, 0xffff0000, v146
    v_lshlrev_b32 v46, 16, v147
    v_and_b32 v47, 0xffff0000, v147
    v_cvt_pk_bf16_f32 v32, v32, v32
    v_and_b32 v32, 0xffff0000, v32
    v_add_f32 v32, v32, v40
    v_cvt_pk_bf16_f32 v32, v32, v32
    v_and_b32 v32, 0xffff0000, v32
    v_max_f32 v32, 0, v32
    v_mul_f32 v32, v32, v32
    v_cvt_pk_bf16_f32 v32, v32, v32
    v_cvt_pk_bf16_f32 v33, v33, v33
    v_and_b32 v33, 0xffff0000, v33
    v_add_f32 v33, v33, v41
    v_cvt_pk_bf16_f32 v33, v33, v33
    v_and_b32 v33, 0xffff0000, v33
    v_max_f32 v33, 0, v33
    v_mul_f32 v33, v33, v33
    v_cvt_pk_bf16_f32 v33, v33, v33
    v_cvt_pk_bf16_f32 v34, v34, v34
    v_and_b32 v34, 0xffff0000, v34
    v_add_f32 v34, v34, v42
    v_cvt_pk_bf16_f32 v34, v34, v34
    v_and_b32 v34, 0xffff0000, v34
    v_max_f32 v34, 0, v34
    v_mul_f32 v34, v34, v34
    v_cvt_pk_bf16_f32 v34, v34, v34
    v_cvt_pk_bf16_f32 v35, v35, v35
    v_and_b32 v35, 0xffff0000, v35
    v_add_f32 v35, v35, v43
    v_cvt_pk_bf16_f32 v35, v35, v35
    v_and_b32 v35, 0xffff0000, v35
    v_max_f32 v35, 0, v35
    v_mul_f32 v35, v35, v35
    v_cvt_pk_bf16_f32 v35, v35, v35
    v_cvt_pk_bf16_f32 v36, v36, v36
    v_and_b32 v36, 0xffff0000, v36
    v_add_f32 v36, v36, v44
    v_cvt_pk_bf16_f32 v36, v36, v36
    v_and_b32 v36, 0xffff0000, v36
    v_max_f32 v36, 0, v36
    v_mul_f32 v36, v36, v36
    v_cvt_pk_bf16_f32 v36, v36, v36
    v_cvt_pk_bf16_f32 v37, v37, v37
    v_and_b32 v37, 0xffff0000, v37
    v_add_f32 v37, v37, v45
    v_cvt_pk_bf16_f32 v37, v37, v37
    v_and_b32 v37, 0xffff0000, v37
    v_max_f32 v37, 0, v37
    v_mul_f32 v37, v37, v37
    v_cvt_pk_bf16_f32 v37, v37, v37
    v_cvt_pk_bf16_f32 v38, v38, v38
    v_and_b32 v38, 0xffff0000, v38
    v_add_f32 v38, v38, v46
    v_cvt_pk_bf16_f32 v38, v38, v38
    v_and_b32 v38, 0xffff0000, v38
    v_max_f32 v38, 0, v38
    v_mul_f32 v38, v38, v38
    v_cvt_pk_bf16_f32 v38, v38, v38
    v_cvt_pk_bf16_f32 v39, v39, v39
    v_and_b32 v39, 0xffff0000, v39
    v_add_f32 v39, v39, v47
    v_cvt_pk_bf16_f32 v39, v39, v39
    v_and_b32 v39, 0xffff0000, v39
    v_max_f32 v39, 0, v39
    v_mul_f32 v39, v39, v39
    v_cvt_pk_bf16_f32 v39, v39, v39
    v_bfe_u32 v24, v1, 2, 1
    v_mul_u32_u24 v24, 192, v24
    v_and_b32 v25, 3, v1
    v_lshl_add_u32 v24, v25, 2, v24
    v_add_u32 v24, 131216, v24
    s_mov_b64 exec, 0xff
    ds_write_b32 v24, v32 offset:0
    ds_write_b32 v24, v33 offset:48
    ds_write_b32 v24, v34 offset:96
    ds_write_b32 v24, v35 offset:144
    s_cmp_lg_u32 s82, 0
    s_cbranch_scc1 L_eh5
    s_mov_b64 exec, 0x11
    ds_write_b32 v24, v36 offset:16
    ds_write_b32 v24, v37 offset:64
    ds_write_b32 v24, v38 offset:112
    ds_write_b32 v24, v39 offset:160
L_eh5:
    s_mov_b64 exec, 1
    ds_add_u32 v2, v3 offset:24
    s_mov_b64 exec, -1
    s_branch L_ew
L_eg:
    v_and_b32 v25, 31, v1
    v_mul_u32_u24 v25, 36, v25
    v_lshrrev_b32 v26, 5, v1
    v_mul_u32_u24 v26, 1152, v26
    v_add_u32 v26, v26, v25
    buffer_load_dwordx3 v[64:66], v26, s[60:63], 0 offen offset:0
    buffer_load_dwordx3 v[80:82], v25, s[72:75], 0 offen offset:0
    buffer_load_dwordx3 v[68:70], v26, s[60:63], 0 offen offset:12
    buffer_load_dwordx3 v[84:86], v25, s[72:75], 0 offen offset:12
    buffer_load_dwordx3 v[72:74], v26, s[60:63], 0 offen offset:24
    buffer_load_dwordx3 v[88:90], v25, s[72:75], 0 offen offset:24
    s_waitcnt vmcnt(0)
    v_lshlrev_b32 v24, 16, v64
    v_lshlrev_b32 v25, 16, v80
    v_mul_f32 v24, v24, v25
    v_and_b32 v25, 0xffff0000, v64
    v_and_b32 v26, 0xffff0000, v80
    v_mul_f32 v25, v25, v26
    v_cvt_pk_bf16_f32 v24, v24, v25
    v_lshlrev_b32 v25, 16, v24
    v_and_b32 v24, 0xffff0000, v24
    v_add_f32 v32, v24, v25
    v_lshlrev_b32 v24, 16, v65
    v_lshlrev_b32 v25, 16, v81
    v_mul_f32 v24, v24, v25
    v_and_b32 v25, 0xffff0000, v65
    v_and_b32 v26, 0xffff0000, v81
    v_mul_f32 v25, v25, v26
    v_cvt_pk_bf16_f32 v24, v24, v25
    v_lshlrev_b32 v25, 16, v24
    v_and_b32 v24, 0xffff0000, v24
    v_add_f32 v32, v32, v24
    v_add_f32 v32, v32, v25
    v_lshlrev_b32 v24, 16, v66
    v_lshlrev_b32 v25, 16, v82
    v_mul_f32 v24, v24, v25
    v_and_b32 v25, 0xffff0000, v66
    v_and_b32 v26, 0xffff0000, v82
    v_mul_f32 v25, v25, v26
    v_cvt_pk_bf16_f32 v24, v24, v25
    v_lshlrev_b32 v25, 16, v24
    v_and_b32 v24, 0xffff0000, v24
    v_add_f32 v32, v32, v24
    v_add_f32 v32, v32, v25
    v_lshlrev_b32 v24, 16, v68
    v_lshlrev_b32 v25, 16, v84
    v_mul_f32 v24, v24, v25
    v_and_b32 v25, 0xffff0000, v68
    v_and_b32 v26, 0xffff0000, v84
    v_mul_f32 v25, v25, v26
    v_cvt_pk_bf16_f32 v24, v24, v25
    v_lshlrev_b32 v25, 16, v24
    v_and_b32 v24, 0xffff0000, v24
    v_add_f32 v32, v32, v24
    v_add_f32 v32, v32, v25
    v_lshlrev_b32 v24, 16, v69
    v_lshlrev_b32 v25, 16, v85
    v_mul_f32 v24, v24, v25
    v_and_b32 v25, 0xffff0000, v69
    v_and_b32 v26, 0xffff0000, v85
    v_mul_f32 v25, v25, v26
    v_cvt_pk_bf16_f32 v24, v24, v25
    v_lshlrev_b32 v25, 16, v24
    v_and_b32 v24, 0xffff0000, v24
    v_add_f32 v32, v32, v24
    v_add_f32 v32, v32, v25
    v_lshlrev_b32 v24, 16, v70
    v_lshlrev_b32 v25, 16, v86
    v_mul_f32 v24, v24, v25
    v_and_b32 v25, 0xffff0000, v70
    v_and_b32 v26, 0xffff0000, v86
    v_mul_f32 v25, v25, v26
    v_cvt_pk_bf16_f32 v24, v24, v25
    v_lshlrev_b32 v25, 16, v24
    v_and_b32 v24, 0xffff0000, v24
    v_add_f32 v32, v32, v24
    v_add_f32 v32, v32, v25
    v_lshlrev_b32 v24, 16, v72
    v_lshlrev_b32 v25, 16, v88
    v_mul_f32 v24, v24, v25
    v_and_b32 v25, 0xffff0000, v72
    v_and_b32 v26, 0xffff0000, v88
    v_mul_f32 v25, v25, v26
    v_cvt_pk_bf16_f32 v24, v24, v25
    v_lshlrev_b32 v25, 16, v24
    v_and_b32 v24, 0xffff0000, v24
    v_add_f32 v32, v32, v24
    v_add_f32 v32, v32, v25
    v_lshlrev_b32 v24, 16, v73
    v_lshlrev_b32 v25, 16, v89
    v_mul_f32 v24, v24, v25
    v_and_b32 v25, 0xffff0000, v73
    v_and_b32 v26, 0xffff0000, v89
    v_mul_f32 v25, v25, v26
    v_cvt_pk_bf16_f32 v24, v24, v25
    v_lshlrev_b32 v25, 16, v24
    v_and_b32 v24, 0xffff0000, v24
    v_add_f32 v32, v32, v24
    v_add_f32 v32, v32, v25
    v_lshlrev_b32 v24, 16, v74
    v_lshlrev_b32 v25, 16, v90
    v_mul_f32 v24, v24, v25
    v_and_b32 v25, 0xffff0000, v74
    v_and_b32 v26, 0xffff0000, v90
    v_mul_f32 v25, v25, v26
    v_cvt_pk_bf16_f32 v24, v24, v25
    v_lshlrev_b32 v25, 16, v24
    v_and_b32 v24, 0xffff0000, v24
    v_add_f32 v32, v32, v24
    v_add_f32 v32, v32, v25
    s_nop 1
    v_add_f32_dpp v32, v32, v32 row_ror:8 row_mask:0xf bank_mask:0xf
    s_nop 1
    v_add_f32_dpp v32, v32, v32 row_ror:4 row_mask:0xf bank_mask:0xf
    s_nop 1
    v_add_f32_dpp v32, v32, v32 row_ror:2 row_mask:0xf bank_mask:0xf
    s_nop 1
    v_add_f32_dpp v32, v32, v32 row_ror:1 row_mask:0xf bank_mask:0xf
    v_mov_b32 v24, v32
    s_nop 1
    v_permlane16_swap_b32 v32, v24
    v_add_f32 v32, v32, v24
    v_cvt_pk_bf16_f32 v32, v32, v32
    v_and_b32 v32, 0xffff0000, v32
    v_mul_f32 v32, 0xbfb8aa3b, v32
    v_exp_f32 v32, v32
    s_nop 0
    v_add_f32 v32, 1.0, v32
    v_rcp_f32 v32, v32
    s_nop 0
    v_cvt_pk_bf16_f32 v32, v32, v32
    v_and_b32 v32, 0xffff0000, v32
    v_sub_f32 v33, 1.0, v32
    v_cvt_pk_bf16_f32 v33, v33, v33
    v_and_b32 v33, 0xffff0000, v33
    v_lshrrev_b32 v24, 1, v1
    v_add_u32 v24, 131584, v24
    s_mov_b32 exec_lo, 1
    s_mov_b32 exec_hi, 1
    ds_write_b64 v24, v[32:33]
    s_mov_b64 exec, 1
    ds_add_u32 v2, v3 offset:24
    s_mov_b64 exec, -1
L_ew:
    s_mul_i32 s84, s97, 384
    v_mul_u32_u24 v24, 1152, v22
    v_add_u32 v24, s84, v24
    v_lshl_add_u32 v8, v23, 4, v24
    v_lshl_add_u32 v9, v23, 3, v24
    v_add_u32 v9, 256, v9
    s_lshl_b32 s84, s82, 30
    v_add_u32 v10, s84, v8
    v_add_u32 v11, s84, v9
    v_and_b32 v24, 1, v23
    v_lshlrev_b32 v24, 4, v24
    v_mov_b32 v25, 0xffff
    v_lshlrev_b32 v24, v24, v25
    v_bfe_u32 v25, v23, 1, 2
    v_and_b32 v26, 10, v23
    v_cmp_eq_u32 vcc, 0, v25
    s_nop 1
    v_cndmask_b32 v4, 0, v24, vcc
    v_cmp_eq_u32 vcc, 1, v25
    s_nop 1
    v_cndmask_b32 v5, 0, v24, vcc
    v_cmp_eq_u32 vcc, 2, v25
    s_nop 1
    v_cndmask_b32 v6, 0, v24, vcc
    v_cmp_eq_u32 vcc, 3, v25
    s_nop 1
    v_cndmask_b32 v7, 0, v24, vcc
    v_cmp_eq_u32 vcc, 0, v26
    s_nop 1
    v_cndmask_b32 v14, 0, v24, vcc
    v_cmp_eq_u32 vcc, 2, v26
    s_nop 1
    v_cndmask_b32 v15, 0, v24, vcc
    v_lshrrev_b32 v24, 3, v23
    v_lshl_add_u32 v24, v24, 2, v22
    v_mul_u32_u24 v24, 48, v24
    v_add_u32 v86, 131200, v24
    v_bfe_u32 v24, v23, 2, 1
    v_lshl_add_u32 v24, v24, 2, v22
    v_mul_u32_u24 v24, 48, v24
    v_add_u32 v87, 131200, v24
    v_lshrrev_b32 v24, 5, v1
    v_lshlrev_b32 v24, 4, v24
    v_add_u32 v88, 131584, v24
    v_and_b32 v24, 1, v22
    v_lshlrev_b32 v24, 4, v24
    v_add_u32 v89, 131584, v24
    v_lshrrev_b32 v24, 2, v1
    v_lshlrev_b32 v24, 14, v24
    v_and_b32 v25, 3, v1
    v_lshl_add_u32 v90, v25, 4, v24
    s_lshl_b32 s85, s42, 6
    s_mul_i32 s43, s97, 393216
    s_add_u32 s43, s43, s85
    s_add_u32 s43, s43, 0x200000
    s_add_u32 s83, s43, 262144
    s_mul_i32 s85, s42, 18432
    s_mul_i32 s86, s80, 4608
    s_mov_b32 s88, 0
L_spin_24:
    ds_read_b32 v27, v2 offset:28
    s_add_u32 s88, s88, 1
    s_waitcnt lgkmcnt(0)
    v_readfirstlane_b32 s87, v27
    s_cmp_ge_u32 s87, 8
    s_cbranch_scc1 L_spd_25
    s_sleep 1
    s_cmp_lt_u32 s88, 262144
    s_cbranch_scc1 L_spin_24
L_spd_25:
    s_add_u32 s84, s86, 0
    buffer_load_dwordx4 v[48:51], v8, s[52:55], s84 offen nt
    buffer_load_dwordx2 v[76:77], v9, s[52:55], s84 offen nt
    s_add_u32 s84, s86, 4608
    buffer_load_dwordx4 v[52:55], v8, s[52:55], s84 offen nt
    buffer_load_dwordx2 v[78:79], v9, s[52:55], s84 offen nt
    s_add_u32 s84, s86, 9216
    buffer_load_dwordx4 v[56:59], v8, s[52:55], s84 offen nt
    buffer_load_dwordx2 v[80:81], v9, s[52:55], s84 offen nt
    s_add_u32 s84, s86, 13824
    buffer_load_dwordx4 v[60:63], v8, s[52:55], s84 offen nt
    buffer_load_dwordx2 v[82:83], v9, s[52:55], s84 offen nt
    s_add_u32 s84, s86, 18432
    buffer_load_dwordx4 v[64:67], v10, s[52:55], s84 offen nt
    buffer_load_dwordx2 v[84:85], v11, s[52:55], s84 offen nt
    s_add_u32 s84, s85, 0
    buffer_load_dwordx4 v[32:35], v8, s[48:51], s84 offen nt
    buffer_load_dwordx2 v[68:69], v9, s[48:51], s84 offen nt
    s_add_u32 s84, s85, 4608
    buffer_load_dwordx4 v[36:39], v8, s[48:51], s84 offen nt
    buffer_load_dwordx2 v[70:71], v9, s[48:51], s84 offen nt
    s_add_u32 s84, s85, 9216
    buffer_load_dwordx4 v[40:43], v8, s[48:51], s84 offen nt
    buffer_load_dwordx2 v[72:73], v9, s[48:51], s84 offen nt
    s_add_u32 s84, s85, 13824
    buffer_load_dwordx4 v[44:47], v8, s[48:51], s84 offen nt
    buffer_load_dwordx2 v[74:75], v9, s[48:51], s84 offen nt
    s_mov_b32 s88, 0
L_spin_26:
    ds_read_b32 v27, v2 offset:24
    s_add_u32 s88, s88, 1
    s_waitcnt lgkmcnt(0)
    v_readfirstlane_b32 s87, v27
    s_cmp_ge_u32 s87, 2
    s_cbranch_scc1 L_spd_27
    s_sleep 1
    s_cmp_lt_u32 s88, 262144
    s_cbranch_scc1 L_spin_26
L_spd_27:
    ds_read_b128 v[96:99], v86 offset:16
    ds_read_b32 v100, v86 offset:32
    ds_read_b128 v[108:111], v87 offset:16
    ds_read_b32 v112, v87 offset:32
    ds_read_b64 v[116:117], v88
    ds_read_b64 v[118:119], v89
    s_waitcnt lgkmcnt(0)
    v_and_b32 v136, v96, v4
    v_and_b32 v137, v96, v5
    v_and_b32 v138, v96, v6
    v_and_b32 v139, v96, v7
    v_and_b32 v140, v108, v14
    v_and_b32 v141, v108, v15
    s_waitcnt vmcnt(16)
    s_nop 0
    v_mfma_f32_16x16x32_bf16 v[124:127], v[136:139], v[48:51], 0
    v_mfma_f32_16x16x16_bf16 v[132:135], v[140:141], v[76:77], 0
    v_and_b32 v142, v97, v4
    v_and_b32 v143, v97, v5
    v_and_b32 v144, v97, v6
    v_and_b32 v145, v97, v7
    v_and_b32 v146, v109, v14
    v_and_b32 v147, v109, v15
    s_waitcnt vmcnt(14)
    s_nop 0
    v_mfma_f32_16x16x32_bf16 v[124:127], v[142:145], v[52:55], v[124:127]
    v_mfma_f32_16x16x16_bf16 v[132:135], v[146:147], v[78:79], v[132:135]
    v_and_b32 v148, v98, v4
    v_and_b32 v149, v98, v5
    v_and_b32 v150, v98, v6
    v_and_b32 v151, v98, v7
    v_and_b32 v152, v110, v14
    v_and_b32 v153, v110, v15
    s_waitcnt vmcnt(12)
    s_nop 0
    v_mfma_f32_16x16x32_bf16 v[124:127], v[148:151], v[56:59], v[124:127]
    v_mfma_f32_16x16x16_bf16 v[132:135], v[152:153], v[80:81], v[132:135]
    v_and_b32 v154, v99, v4
    v_and_b32 v155, v99, v5
    v_and_b32 v156, v99, v6
    v_and_b32 v157, v99, v7
    v_and_b32 v158, v111, v14
    v_and_b32 v159, v111, v15
    s_waitcnt vmcnt(10)
    s_nop 0
    v_mfma_f32_16x16x32_bf16 v[124:127], v[154:157], v[60:63], v[124:127]
    v_mfma_f32_16x16x16_bf16 v[132:135], v[158:159], v[82:83], v[132:135]
    v_and_b32 v136, v100, v4
    v_and_b32 v137, v100, v5
    v_and_b32 v138, v100, v6
    v_and_b32 v139, v100, v7
    v_and_b32 v140, v112, v14
    v_and_b32 v141, v112, v15
    s_waitcnt vmcnt(8)
    s_nop 0
    v_mfma_f32_16x16x32_bf16 v[124:127], v[136:139], v[64:67], v[124:127]
    v_mfma_f32_16x16x16_bf16 v[132:135], v[140:141], v[84:85], v[132:135]
    s_mov_b32 s85, 0x07060500
    s_mov_b32 s86, 0x07060501
    s_mov_b32 s14, 0x07060502
    s_mov_b32 s15, 0x07060503
    s_nop 3
    v_mul_f32 v124, v124, v117
    v_mul_f32 v132, v132, v119
    v_mul_f32 v125, v125, v117
    v_mul_f32 v133, v133, v119
    v_mul_f32 v126, v126, v117
    v_mul_f32 v134, v134, v119
    v_mul_f32 v127, v127, v117
    v_mul_f32 v135, v135, v119
    s_mov_b32 s88, 0
L_spin_28:
    s_waitcnt lgkmcnt(0)
    ds_read_b32 v27, v2 offset:16
    ds_read_b128 v[92:95], v86
    ds_read_b128 v[104:107], v87
    s_add_u32 s88, s88, 1
    s_waitcnt lgkmcnt(2)
    v_readfirstlane_b32 s87, v27
    s_cmp_ge_u32 s87, 1
    s_cbranch_scc1 L_spd_29
    s_cmp_lt_u32 s88, 262144
    s_cbranch_scc1 L_spin_28
L_spd_29:
    s_waitcnt lgkmcnt(0)
    v_and_b32 v142, v92, v4
    v_and_b32 v143, v92, v5
    v_and_b32 v144, v92, v6
    v_and_b32 v145, v92, v7
    v_and_b32 v146, v104, v14
    v_and_b32 v147, v104, v15
    s_waitcnt vmcnt(6)
    s_nop 0
    v_mfma_f32_16x16x32_bf16 v[120:123], v[142:145], v[32:35], 0
    v_mfma_f32_16x16x16_bf16 v[128:131], v[146:147], v[68:69], 0
    v_and_b32 v148, v93, v4
    v_and_b32 v149, v93, v5
    v_and_b32 v150, v93, v6
    v_and_b32 v151, v93, v7
    v_and_b32 v152, v105, v14
    v_and_b32 v153, v105, v15
    s_waitcnt vmcnt(4)
    s_nop 0
    v_mfma_f32_16x16x32_bf16 v[120:123], v[148:151], v[36:39], v[120:123]
    v_mfma_f32_16x16x16_bf16 v[128:131], v[152:153], v[70:71], v[128:131]
    v_and_b32 v154, v94, v4
    v_and_b32 v155, v94, v5
    v_and_b32 v156, v94, v6
    v_and_b32 v157, v94, v7
    v_and_b32 v158, v106, v14
    v_and_b32 v159, v106, v15
    s_waitcnt vmcnt(2)
    s_nop 0
    v_mfma_f32_16x16x32_bf16 v[120:123], v[154:157], v[40:43], v[120:123]
    v_mfma_f32_16x16x16_bf16 v[128:131], v[158:159], v[72:73], v[128:131]
    v_and_b32 v136, v95, v4
    v_and_b32 v137, v95, v5
    v_and_b32 v138, v95, v6
    v_and_b32 v139, v95, v7
    v_and_b32 v140, v107, v14
    v_and_b32 v141, v107, v15
    s_waitcnt vmcnt(0)
    s_nop 0
    v_mfma_f32_16x16x32_bf16 v[120:123], v[136:139], v[44:47], v[120:123]
    v_mfma_f32_16x16x16_bf16 v[128:131], v[140:141], v[74:75], v[128:131]
    s_nop 6
    v_fmac_f32 v124, v120, v116
    v_fmac_f32 v125, v121, v116
    v_fmac_f32 v126, v122, v116
    v_fmac_f32 v127, v123, v116
    v_perm_b32 v124, v124, v13, s85
    v_perm_b32 v125, v125, v13, s86
    v_perm_b32 v126, v126, v13, s14
    v_perm_b32 v127, v127, v13, s15
    buffer_store_dwordx4 v[124:127], v90, s[56:59], s43 offen sc1
    v_fmac_f32 v132, v128, v118
    v_fmac_f32 v133, v129, v118
    v_fmac_f32 v134, v130, v118
    v_fmac_f32 v135, v131, v118
    v_perm_b32 v132, v132, v13, s85
    v_perm_b32 v133, v133, v13, s86
    v_perm_b32 v134, v134, v13, s14
    v_perm_b32 v135, v135, v13, s15
    s_mov_b32 exec_lo, -1
    s_mov_b32 exec_hi, 0
    buffer_store_dwordx4 v[132:135], v90, s[56:59], s83 offen sc1
    s_mov_b64 exec, -1
    s_cmp_lt_u32 s2, 72
    s_cbranch_scc1 L_final
    s_branch L_adone
L_amain:
    s_setprio 2
    s_lshl_b32 s81, s97, 14
    v_and_b32 v24, 3, v23
    v_lshlrev_b32 v24, 10, v24
    v_lshrrev_b32 v25, 2, v23
    v_lshl_add_u32 v24, v25, 8, v24
    v_add_u32 v24, s81, v24
    v_add_u32 v25, 0, v22
    v_xor_b32 v25, v25, v23
    v_lshl_add_u32 v12, v25, 4, v24
    v_add_u32 v25, 4, v22
    v_xor_b32 v25, v25, v23
    v_lshl_add_u32 v13, v25, 4, v24
    v_add_u32 v25, 8, v22
    v_xor_b32 v25, v25, v23
    v_lshl_add_u32 v14, v25, 4, v24
    v_add_u32 v25, 12, v22
    v_xor_b32 v25, v25, v23
    v_lshl_add_u32 v15, v25, 4, v24
    v_lshrrev_b32 v24, 3, v23
    v_lshlrev_b32 v24, 8, v24
    v_lshl_add_u32 v17, v22, 4, v24
    v_add_u32 v17, 132352, v17
    v_and_b32 v24, 1, v23
    v_lshlrev_b32 v24, 4, v24
    v_mov_b32 v25, 0xffff
    v_lshlrev_b32 v24, v24, v25
    v_bfe_u32 v25, v23, 1, 2
    v_cmp_eq_u32 vcc, 0, v25
    s_nop 1
    v_cndmask_b32 v4, 0, v24, vcc
    v_cmp_eq_u32 vcc, 1, v25
    s_nop 1
    v_cndmask_b32 v5, 0, v24, vcc
    v_cmp_eq_u32 vcc, 2, v25
    s_nop 1
    v_cndmask_b32 v6, 0, v24, vcc
    v_cmp_eq_u32 vcc, 3, v25
    s_nop 1
    v_cndmask_b32 v7, 0, v24, vcc
    v_lshrrev_b32 v24, 5, v1
    v_lshlrev_b32 v24, 9, v24
    v_lshl_add_u32 v24, v23, 5, v24
    v_and_b32 v25, 1, v22
    v_lshl_add_u32 v24, v25, 4, v24
    s_lshl_b32 s84, s97, 10
    s_add_u32 s84, s84, 133120
    v_add_u32 v8, s84, v24
    s_waitcnt vmcnt(16)
    s_mov_b32 s88, 0
L_spin_30:
    ds_read_b32 v27, v2 offset:4
    s_add_u32 s88, s88, 1
    s_waitcnt lgkmcnt(0)
    v_readfirstlane_b32 s87, v27
    s_cmp_ge_u32 s87, 1
    s_cbranch_scc1 L_spd_31
    s_sleep 1
    s_cmp_lt_u32 s88, 262144
    s_cbranch_scc1 L_spin_30
L_spd_31:
    ds_read_b128 v[112:115], v17 offset:0
    ds_read_b128 v[116:119], v17 offset:64
    ds_read_b128 v[120:123], v17 offset:128
    ds_read_b128 v[124:127], v17 offset:192
    ds_read_b128 v[128:131], v12 offset:0
    ds_read_b128 v[132:135], v13 offset:0
    ds_read_b128 v[136:139], v14 offset:0
    ds_read_b128 v[140:143], v15 offset:0
    ds_read_b128 v[144:147], v12 offset:4096
    ds_read_b128 v[148:151], v13 offset:4096
    ds_read_b128 v[152:155], v14 offset:4096
    ds_read_b128 v[156:159], v15 offset:4096
    s_waitcnt lgkmcnt(4)
    v_mfma_f32_16x16x32_bf16 v[96:99], v[128:131], v[112:115], 0
    v_mfma_f32_16x16x32_bf16 v[96:99], v[132:135], v[116:119], v[96:99]
    v_mfma_f32_16x16x32_bf16 v[96:99], v[136:139], v[120:123], v[96:99]
    v_mfma_f32_16x16x32_bf16 v[96:99], v[140:143], v[124:127], v[96:99]
    ds_read_b128 v[128:131], v12 offset:8192
    ds_read_b128 v[132:135], v13 offset:8192
    ds_read_b128 v[136:139], v14 offset:8192
    ds_read_b128 v[140:143], v15 offset:8192
    s_waitcnt lgkmcnt(4)
    v_mfma_f32_16x16x32_bf16 v[100:103], v[144:147], v[112:115], 0
    v_mfma_f32_16x16x32_bf16 v[100:103], v[148:151], v[116:119], v[100:103]
    v_mfma_f32_16x16x32_bf16 v[100:103], v[152:155], v[120:123], v[100:103]
    v_mfma_f32_16x16x32_bf16 v[100:103], v[156:159], v[124:127], v[100:103]
    ds_read_b128 v[144:147], v12 offset:12288
    ds_read_b128 v[148:151], v13 offset:12288
    ds_read_b128 v[152:155], v14 offset:12288
    ds_read_b128 v[156:159], v15 offset:12288
    s_waitcnt lgkmcnt(4)
    v_mfma_f32_16x16x32_bf16 v[104:107], v[128:131], v[112:115], 0
    v_mfma_f32_16x16x32_bf16 v[104:107], v[132:135], v[116:119], v[104:107]
    v_mfma_f32_16x16x32_bf16 v[104:107], v[136:139], v[120:123], v[104:107]
    v_mfma_f32_16x16x32_bf16 v[104:107], v[140:143], v[124:127], v[104:107]
    s_waitcnt lgkmcnt(0)
    v_mfma_f32_16x16x32_bf16 v[108:111], v[144:147], v[112:115], 0
    v_mfma_f32_16x16x32_bf16 v[108:111], v[148:151], v[116:119], v[108:111]
    v_mfma_f32_16x16x32_bf16 v[108:111], v[152:155], v[120:123], v[108:111]
    v_mfma_f32_16x16x32_bf16 v[108:111], v[156:159], v[124:127], v[108:111]
    s_lshl_b32 s84, s97, 4
    s_add_u32 s84, s84, 131712
    v_max3_f32 v24, v96, v97, v98
    v_max3_f32 v24, v24, v99, v100
    v_max3_f32 v24, v24, v101, v102
    v_max3_f32 v24, v24, v103, v104
    v_max3_f32 v24, v24, v105, v106
    s_nop 3
    v_max3_f32 v24, v24, v107, v108
    v_max3_f32 v24, v24, v109, v110
    v_max_f32 v24, v24, v111
    v_mov_b32 v25, v24
    s_nop 1
    v_permlane32_swap_b32 v24, v25
    v_max_f32 v24, v24, v25
    v_mov_b32 v25, v24
    s_nop 1
    v_permlane16_swap_b32 v24, v25
    v_max_f32 v24, v24, v25
    v_mul_f32 v25, s89, v24
    v_fma_f32 v96, v96, s89, -v25
    v_fma_f32 v97, v97, s89, -v25
    v_fma_f32 v98, v98, s89, -v25
    v_fma_f32 v99, v99, s89, -v25
    v_fma_f32 v100, v100, s89, -v25
    v_fma_f32 v101, v101, s89, -v25
    v_fma_f32 v102, v102, s89, -v25
    v_fma_f32 v103, v103, s89, -v25
    v_fma_f32 v104, v104, s89, -v25
    v_fma_f32 v105, v105, s89, -v25
    v_fma_f32 v106, v106, s89, -v25
    v_fma_f32 v107, v107, s89, -v25
    v_fma_f32 v108, v108, s89, -v25
    v_fma_f32 v109, v109, s89, -v25
    v_fma_f32 v110, v110, s89, -v25
    v_fma_f32 v111, v111, s89, -v25
    v_exp_f32 v96, v96
    v_exp_f32 v97, v97
    v_exp_f32 v98, v98
    v_exp_f32 v99, v99
    v_exp_f32 v100, v100
    v_exp_f32 v101, v101
    v_exp_f32 v102, v102
    v_exp_f32 v103, v103
    v_exp_f32 v104, v104
    v_exp_f32 v105, v105
    v_exp_f32 v106, v106
    v_exp_f32 v107, v107
    v_exp_f32 v108, v108
    v_exp_f32 v109, v109
    v_exp_f32 v110, v110
    v_exp_f32 v111, v111
    s_nop 0
    v_add_f32 v26, v96, v97
    v_add_f32 v26, v26, v98
    v_add_f32 v26, v26, v99
    v_add_f32 v26, v26, v100
    v_add_f32 v26, v26, v101
    v_add_f32 v26, v26, v102
    v_add_f32 v26, v26, v103
    v_add_f32 v26, v26, v104
    v_add_f32 v26, v26, v105
    v_add_f32 v26, v26, v106
    v_add_f32 v26, v26, v107
    v_add_f32 v26, v26, v108
    v_add_f32 v26, v26, v109
    v_add_f32 v26, v26, v110
    v_add_f32 v26, v26, v111
    v_cvt_pk_bf16_f32 v96, v96, v96
    v_cvt_pk_bf16_f32 v97, v97, v97
    v_cvt_pk_bf16_f32 v98, v98, v98
    v_cvt_pk_bf16_f32 v99, v99, v99
    v_cvt_pk_bf16_f32 v100, v100, v100
    v_cvt_pk_bf16_f32 v101, v101, v101
    v_cvt_pk_bf16_f32 v102, v102, v102
    v_cvt_pk_bf16_f32 v103, v103, v103
    v_cvt_pk_bf16_f32 v104, v104, v104
    v_cvt_pk_bf16_f32 v105, v105, v105
    v_cvt_pk_bf16_f32 v106, v106, v106
    v_cvt_pk_bf16_f32 v107, v107, v107
    v_cvt_pk_bf16_f32 v108, v108, v108
    v_cvt_pk_bf16_f32 v109, v109, v109
    v_cvt_pk_bf16_f32 v110, v110, v110
    v_cvt_pk_bf16_f32 v111, v111, v111
    v_mov_b32 v25, v26
    s_nop 1
    v_permlane32_swap_b32 v26, v25
    v_add_f32 v26, v26, v25
    v_mov_b32 v25, v26
    s_nop 1
    v_permlane16_swap_b32 v26, v25
    v_add_f32 v26, v26, v25
    v_mov_b32 v25, v26
    v_add_u32 v26, s84, v1
    s_mov_b64 exec, 0x101
    ds_write_b64 v26, v[24:25]
    s_mov_b64 exec, 1
    ds_add_u32 v2, v3 offset:8
    s_mov_b64 exec, -1
    v_and_b32 v128, v96, v4
    v_and_b32 v129, v96, v5
    v_and_b32 v130, v96, v6
    v_and_b32 v131, v96, v7
    s_waitcnt vmcnt(15)
    s_nop 0
    v_mfma_f32_16x16x32_bf16 v[28:31], v[128:131], v[32:35], 0
    v_and_b32 v132, v97, v4
    v_and_b32 v133, v97, v5
    v_and_b32 v134, v97, v6
    v_and_b32 v135, v97, v7
    s_waitcnt vmcnt(14)
    s_nop 0
    v_mfma_f32_16x16x32_bf16 v[28:31], v[132:135], v[36:39], v[28:31]
    v_and_b32 v136, v98, v4
    v_and_b32 v137, v98, v5
    v_and_b32 v138, v98, v6
    v_and_b32 v139, v98, v7
    s_waitcnt vmcnt(13)
    s_nop 0
    v_mfma_f32_16x16x32_bf16 v[28:31], v[136:139], v[40:43], v[28:31]
    v_and_b32 v140, v99, v4
    v_and_b32 v141, v99, v5
    v_and_b32 v142, v99, v6
    v_and_b32 v143, v99, v7
    s_waitcnt vmcnt(12)
    s_nop 0
    v_mfma_f32_16x16x32_bf16 v[28:31], v[140:143], v[44:47], v[28:31]
    v_and_b32 v144, v100, v4
    v_and_b32 v145, v100, v5
    v_and_b32 v146, v100, v6
    v_and_b32 v147, v100, v7
    s_waitcnt vmcnt(11)
    s_nop 0
    v_mfma_f32_16x16x32_bf16 v[28:31], v[144:147], v[48:51], v[28:31]
    v_and_b32 v148, v101, v4
    v_and_b32 v149, v101, v5
    v_and_b32 v150, v101, v6
    v_and_b32 v151, v101, v7
    s_waitcnt vmcnt(10)
    s_nop 0
    v_mfma_f32_16x16x32_bf16 v[28:31], v[148:151], v[52:55], v[28:31]
    v_and_b32 v152, v102, v4
    v_and_b32 v153, v102, v5
    v_and_b32 v154, v102, v6
    v_and_b32 v155, v102, v7
    s_waitcnt vmcnt(9)
    s_nop 0
    v_mfma_f32_16x16x32_bf16 v[28:31], v[152:155], v[56:59], v[28:31]
    v_and_b32 v156, v103, v4
    v_and_b32 v157, v103, v5
    v_and_b32 v158, v103, v6
    v_and_b32 v159, v103, v7
    s_waitcnt vmcnt(8)
    s_nop 0
    v_mfma_f32_16x16x32_bf16 v[28:31], v[156:159], v[60:63], v[28:31]
    v_and_b32 v128, v104, v4
    v_and_b32 v129, v104, v5
    v_and_b32 v130, v104, v6
    v_and_b32 v131, v104, v7
    s_waitcnt vmcnt(7)
    s_nop 0
    v_mfma_f32_16x16x32_bf16 v[28:31], v[128:131], v[64:67], v[28:31]
    v_and_b32 v132, v105, v4
    v_and_b32 v133, v105, v5
    v_and_b32 v134, v105, v6
    v_and_b32 v135, v105, v7
    s_waitcnt vmcnt(6)
    s_nop 0
    v_mfma_f32_16x16x32_bf16 v[28:31], v[132:135], v[68:71], v[28:31]
    v_and_b32 v136, v106, v4
    v_and_b32 v137, v106, v5
    v_and_b32 v138, v106, v6
    v_and_b32 v139, v106, v7
    s_waitcnt vmcnt(5)
    s_nop 0
    v_mfma_f32_16x16x32_bf16 v[28:31], v[136:139], v[72:75], v[28:31]
    v_and_b32 v140, v107, v4
    v_and_b32 v141, v107, v5
    v_and_b32 v142, v107, v6
    v_and_b32 v143, v107, v7
    s_waitcnt vmcnt(4)
    s_nop 0
    v_mfma_f32_16x16x32_bf16 v[28:31], v[140:143], v[76:79], v[28:31]
    v_and_b32 v144, v108, v4
    v_and_b32 v145, v108, v5
    v_and_b32 v146, v108, v6
    v_and_b32 v147, v108, v7
    s_waitcnt vmcnt(3)
    s_nop 0
    v_mfma_f32_16x16x32_bf16 v[28:31], v[144:147], v[80:83], v[28:31]
    v_and_b32 v148, v109, v4
    v_and_b32 v149, v109, v5
    v_and_b32 v150, v109, v6
    v_and_b32 v151, v109, v7
    s_waitcnt vmcnt(2)
    s_nop 0
    v_mfma_f32_16x16x32_bf16 v[28:31], v[148:151], v[84:87], v[28:31]
    v_and_b32 v152, v110, v4
    v_and_b32 v153, v110, v5
    v_and_b32 v154, v110, v6
    v_and_b32 v155, v110, v7
    s_waitcnt vmcnt(1)
    s_nop 0
    v_mfma_f32_16x16x32_bf16 v[28:31], v[152:155], v[88:91], v[28:31]
    v_and_b32 v156, v111, v4
    v_and_b32 v157, v111, v5
    v_and_b32 v158, v111, v6
    v_and_b32 v159, v111, v7
    s_waitcnt vmcnt(0)
    s_nop 0
    v_mfma_f32_16x16x32_bf16 v[28:31], v[156:159], v[92:95], v[28:31]
    s_nop 7
    ds_write_b128 v8, v[28:31]
    s_mov_b64 exec, 1
    ds_add_u32 v2, v3 offset:12
    s_mov_b64 exec, -1
L_adone:
L_end:
    s_endpgm
.section .rodata,"a"
.p2align 6
.amdhsa_kernel gated_mix__sliding_block_cached__dense_activation_squared_relu__decode_kernel
  .amdhsa_next_free_vgpr 168
  .amdhsa_next_free_sgpr 102
  .amdhsa_accum_offset 168
  .amdhsa_group_segment_fixed_size 0
  .amdhsa_kernarg_size 112
  .amdhsa_user_sgpr_count 2
  .amdhsa_user_sgpr_kernarg_segment_ptr 1
  .amdhsa_system_sgpr_workgroup_id_x 1
.end_amdhsa_kernel
```
